```python
import torch

def _softmax(x, axis=-1):
    return torch.softmax(x, dim=axis)
def _gelu(x):
    return torch.nn.functional.gelu(x, approximate="tanh")
def _silu(x):
    return torch.nn.functional.silu(x)
def _sigmoid(x):
    return torch.sigmoid(x)
def _layernorm(x, axis=-1, eps=1e-5):
    m = x.mean(dim=axis, keepdim=True)
    v = x.var(dim=axis, keepdim=True, unbiased=False)
    return (x - m) / torch.sqrt(v + eps)
def _scatter_add(tgt, idx, src, axis=0):
    return tgt.clone().index_add_(axis, idx, src)
def _segment_sum(src, seg, n):
    out = torch.zeros((n,) + src.shape[1:], dtype=src.dtype)
    return out.index_add_(0, seg, src)
def _pad(x, pw):
    flat = tuple(v for pair in reversed(pw) for v in pair)
    return torch.nn.functional.pad(x, flat)

kernel_name = 'gated_mix__ssm_conv_h3__geglu_ffn__prompt'

def setup_inputs():

    _w = (lambda a: (lambda t: t.to(torch.bfloat16) if t.is_floating_point() else t)(torch.as_tensor(a)))
    def _A_setup():
        B, S, D = 1, 2048, 512
        ks = 4
        return {
            "q": _w((lambda *s: torch.randn(*s, dtype=torch.bfloat16) * 0.05)(B, S, D)),
            "k": _w((lambda *s: torch.randn(*s, dtype=torch.bfloat16) * 0.2)(B, S, D)),
            "v": _w((lambda *s: torch.randn(*s, dtype=torch.bfloat16) * 0.2)(B, S, D)),
            "shift_k": _w((lambda *s: torch.randn(*s, dtype=torch.bfloat16) * 0.2)(D, ks) * 0.5),
            "ssm_k": _w((lambda *s: torch.randn(*s, dtype=torch.bfloat16) * 0.8)(D, S) * (1.0 / S ** 0.5)),
            "ssm_D": _w((lambda *s: torch.randn(*s, dtype=torch.bfloat16) * 0.2)(D)),
        }
    _A_in = _A_setup()

    def _B_setup():
        B, S, D, F = 1, 2048, 512, 1376
        return {
            "x": _w((lambda *s: torch.randn(*s, dtype=torch.bfloat16) * 0.05)(B, S, D)),
            "w_gate": _w((lambda *s: torch.randn(*s, dtype=torch.bfloat16) * 0.05)(D, F)),
            "w_up": _w((lambda *s: torch.randn(*s, dtype=torch.bfloat16) * 0.05)(D, F)),
            "w_down": _w((lambda *s: torch.randn(*s, dtype=torch.bfloat16) * 0.05)(F, D)),
        }
    _B_in = _B_setup()

    return {
        "A_q": _A_in["q"],
        "A_k": _A_in["k"],
        "A_v": _A_in["v"],
        "A_shift_k": _A_in["shift_k"],
        "A_ssm_k": _A_in["ssm_k"],
        "A_ssm_D": _A_in["ssm_D"],
        "B_x": _B_in["x"],
        "B_w_gate": _B_in["w_gate"],
        "B_w_up": _B_in["w_up"],
        "B_w_down": _B_in["w_down"],
        "gate_w": _w((lambda *s: torch.randn(*s, dtype=torch.bfloat16) * 0.05)(512) * 16.0),
    }

def reference(A_q, A_k, A_v, A_shift_k, A_ssm_k, A_ssm_D, B_x, B_w_gate, B_w_up, B_w_down, gate_w):
    def _A_ref(q, k, v, shift_k, ssm_k, ssm_D):
        B, S, D = q.shape
        ks = shift_k.shape[-1]
        k_pad = _pad(k, ((0, 0), (ks - 1, 0), (0, 0)))
        k_shift = torch.zeros_like(k)
        for t in range(ks):
            k_shift = k_shift + k_pad[:, t:t + S, :] * shift_k[:, ks - 1 - t][None, None, :]
        kv = k_shift * v
        L = 2 * S
        kv_pad = _pad(kv, ((0, 0), (0, S), (0, 0)))
        kf_pad = _pad(ssm_k, ((0, 0), (0, S)))
        kv_f = (lambda x, axes=(-2,-1): torch.fft.rfft2(x.float(), dim=axes))(kv_pad[:, None, :, :], axes=(1, 2))
        kf_f = (lambda x, axes=(-2,-1): torch.fft.rfft2(x.float(), dim=axes))(kf_pad[:, None, :], axes=(1, 2))
        kf_f = (lambda x, *d: x.permute(*d))(kf_f, 1, 2, 0)
        y_f = kv_f * kf_f[None, :, :, :]
        y = (lambda x, s, axes=(-2,-1): torch.fft.irfft2(x, s=s, dim=axes).to(torch.bfloat16))(y_f, (1, L), axes=(1, 2))[:, 0, :S, :]
        y = y + kv * ssm_D[None, None, :]
        return q * y

    def _B_ref(x, w_gate, w_up, w_down):
        return (_gelu(x @ w_gate) * (x @ w_up)) @ w_down

    x = A_q
    g = _sigmoid((x * gate_w).sum(-1, keepdims=True))
    a = _A_ref(x, A_k, A_v, A_shift_k, A_ssm_k, A_ssm_D)
    b = _B_ref(x, B_w_gate, B_w_up, B_w_down)
    return g * a + (1 - g) * b
```

```asm
; @launch kernel=gmix_phase1_kernel grid=(256,1,1) block=(512,1,1) lds=159808
; @launch kernel=gmix_phase2_kernel grid=(256,1,1) block=(512,1,1) lds=156992
.amdgcn_target "amdgcn-amd-amdhsa--gfx950"
.text
    .globl gmix_phase1_kernel
    .p2align 8
    .type gmix_phase1_kernel,@function
gmix_phase1_kernel:
    s_cmp_ge_u32 s2, 256
    s_cbranch_scc1 gmix_phase1_kernel_end
    s_load_dwordx16 s[16:31], s[0:1], 0
    s_load_dwordx8 s[32:39], s[0:1], 64
    s_load_dwordx2 s[42:43], s[0:1], 104
    v_and_b32 v1, 63, v0
    v_lshrrev_b32 v2, 6, v0
    s_and_b32 s4, s2, 7
    v_readfirstlane_b32 s101, v2
    s_lshr_b32 s5, s2, 3
    s_and_b32 s6, s4, 1
    s_lshl_b32 s6, s6, 3
    s_and_b32 s7, s5, 7
    s_add_u32 s6, s6, s7
    s_lshr_b32 s7, s4, 1
    s_lshl_b32 s7, s7, 2
    s_lshr_b32 s8, s5, 3
    s_add_u32 s7, s7, s8
    v_lshrrev_b32 v2, 2, v1
    v_and_b32 v3, 3, v1
    v_lshlrev_b32 v7, 4, v1
    s_and_b32 s3, s101, 3
    s_lshr_b32 s9, s3, 1
    s_and_b32 s11, s3, 1
    s_cmp_ge_u32 s101, 4
    s_cbranch_scc1 gmix_phase1_kernel_helper
    s_cmp_eq_u32 s7, 15
    s_cbranch_scc0 gmix_phase1_kernel_normal
    v_lshrrev_b32 v13, 1, v1
    v_lshlrev_b32 v13, 10, v13
    v_and_b32 v14, 1, v1
    s_add_u32 s95, s5, 6
    v_add_u32 v14, s95, v14
    v_and_b32 v14, 7, v14
    v_lshl_add_u32 v13, v14, 7, v13
    s_lshl_b32 s14, s6, 17
    s_lshl_b32 s95, s3, 15
    s_add_u32 s14, s14, s95
    s_waitcnt lgkmcnt(0)
    s_mov_b32 s44, s16
    s_mov_b32 s45, s17
    s_mov_b32 s46, 2097152
    s_mov_b32 s47, 0x00020000
    buffer_load_dword v120, v13, s[44:47], s14 offen
    s_barrier
    s_barrier
    s_barrier
    s_barrier
    s_barrier
    s_barrier
    s_barrier
    s_barrier
    s_barrier
    s_barrier
    s_barrier
    s_barrier
    s_barrier
    s_barrier
    s_barrier
    s_barrier
    s_endpgm
gmix_phase1_kernel_normal:
    s_setprio 1
    v_and_b32 v14, 31, v1
    v_lshrrev_b32 v15, 5, v1
    v_bfe_u32 v13, v1, 1, 3
    v_xor_b32 v13, v13, v15
    v_lshlrev_b32 v13, 4, v13
    v_lshl_add_u32 v13, v14, 7, v13
    s_lshl_b32 s94, s9, 13
    v_add_u32 v104, s94, v13
    v_xor_b32 v105, 32, v104
    v_xor_b32 v106, 64, v104
    v_xor_b32 v107, 96, v104
    v_bfe_u32 v13, v1, 4, 1
    v_mul_u32_u24 v14, 6176, v13
    v_lshl_add_u32 v14, v15, 9, v14
    v_bfe_u32 v13, v1, 2, 2
    v_lshl_add_u32 v14, v13, 6, v14
    v_lshl_add_u32 v14, v3, 3, v14
    v_add_u32 v14, 65536, v14
    s_mul_i32 s95, s11, 2048
    s_add_u32 s95, s95, 0
    s_cmp_eq_u32 s11, 0
    s_cselect_b32 s94, 0, 32
    v_xor_b32 v13, s94, v14
    v_add_u32 v108, s95, v13
    v_mov_b32 v112, v108
    s_mul_i32 s95, s11, 4096
    s_add_u32 s95, s95, 0
    s_cmp_eq_u32 s11, 0
    s_cselect_b32 s94, 32, 0
    v_xor_b32 v13, s94, v14
    v_add_u32 v109, s95, v13
    v_mov_b32 v113, v109
    s_mul_i32 s95, s11, 2048
    s_add_u32 s95, s95, 2048
    s_cmp_eq_u32 s11, 0
    s_cselect_b32 s94, 0, 32
    v_xor_b32 v13, s94, v14
    v_add_u32 v110, s95, v13
    v_mov_b32 v114, v110
    v_mov_b32 v160, 0
    v_mov_b32 v161, 0
    v_mov_b32 v162, 0
    v_mov_b32 v163, 0
    v_mov_b32 v164, 0
    v_mov_b32 v165, 0
    v_mov_b32 v166, 0
    v_mov_b32 v167, 0
    v_mov_b32 v168, 0
    v_mov_b32 v169, 0
    v_mov_b32 v170, 0
    v_mov_b32 v171, 0
    v_mov_b32 v172, 0
    v_mov_b32 v173, 0
    v_mov_b32 v174, 0
    v_mov_b32 v175, 0
    v_mov_b32 v176, 0
    v_mov_b32 v177, 0
    v_mov_b32 v178, 0
    v_mov_b32 v179, 0
    v_mov_b32 v180, 0
    v_mov_b32 v181, 0
    v_mov_b32 v182, 0
    v_mov_b32 v183, 0
    v_mov_b32 v184, 0
    v_mov_b32 v185, 0
    v_mov_b32 v186, 0
    v_mov_b32 v187, 0
    v_mov_b32 v188, 0
    v_mov_b32 v189, 0
    v_mov_b32 v190, 0
    v_mov_b32 v191, 0
    v_mov_b32 v192, 0
    v_mov_b32 v193, 0
    v_mov_b32 v194, 0
    v_mov_b32 v195, 0
    v_mov_b32 v196, 0
    v_mov_b32 v197, 0
    v_mov_b32 v198, 0
    v_mov_b32 v199, 0
    v_mov_b32 v200, 0
    v_mov_b32 v201, 0
    v_mov_b32 v202, 0
    v_mov_b32 v203, 0
    v_mov_b32 v204, 0
    v_mov_b32 v205, 0
    v_mov_b32 v206, 0
    v_mov_b32 v207, 0
    v_mov_b32 v208, 0
    v_mov_b32 v209, 0
    v_mov_b32 v210, 0
    v_mov_b32 v211, 0
    v_mov_b32 v212, 0
    v_mov_b32 v213, 0
    v_mov_b32 v214, 0
    v_mov_b32 v215, 0
    v_mov_b32 v216, 0
    v_mov_b32 v217, 0
    v_mov_b32 v218, 0
    v_mov_b32 v219, 0
    v_mov_b32 v220, 0
    v_mov_b32 v221, 0
    v_mov_b32 v222, 0
    v_mov_b32 v223, 0
    v_mov_b32 v224, 0
    v_mov_b32 v225, 0
    v_mov_b32 v226, 0
    v_mov_b32 v227, 0
    v_mov_b32 v228, 0
    v_mov_b32 v229, 0
    v_mov_b32 v230, 0
    v_mov_b32 v231, 0
    v_mov_b32 v232, 0
    v_mov_b32 v233, 0
    v_mov_b32 v234, 0
    v_mov_b32 v235, 0
    v_mov_b32 v236, 0
    v_mov_b32 v237, 0
    v_mov_b32 v238, 0
    v_mov_b32 v239, 0
    v_mov_b32 v240, 0
    v_mov_b32 v241, 0
    v_mov_b32 v242, 0
    v_mov_b32 v243, 0
    v_mov_b32 v244, 0
    v_mov_b32 v245, 0
    v_mov_b32 v246, 0
    v_mov_b32 v247, 0
    v_mov_b32 v248, 0
    v_mov_b32 v249, 0
    v_mov_b32 v250, 0
    v_mov_b32 v251, 0
    v_mov_b32 v252, 0
    v_mov_b32 v253, 0
    v_mov_b32 v254, 0
    v_mov_b32 v255, 0
    s_lshl_b32 s12, s6, 2
    s_lshl_b32 s94, s9, 1
    s_add_u32 s12, s12, s94
    s_mul_i32 s12, s12, 86
    s_mul_i32 s13, s7, 6
    s_mul_i32 s94, s11, 3
    s_add_u32 s13, s13, s94
    s_add_u32 s12, s12, s13
    s_lshl_b32 s12, s12, 10
    s_add_u32 s12, s12, 8388608
    v_mov_b32 v20, 0xc0135761
    v_mov_b32 v21, 0xc0135761
    v_mov_b32 v22, 0xbdd2d3e8
    v_mov_b32 v23, 0xbdd2d3e8
    v_mov_b32 v24, 1.0
    v_mov_b32 v25, 1.0
    s_mov_b32 s96, 0
    s_mov_b32 s97, 0
    s_waitcnt lgkmcnt(0)
    s_mov_b32 s76, s42
    s_mov_b32 s77, s43
    s_mov_b32 s78, 16777216
    s_mov_b32 s79, 0x00020000
    s_barrier
    ds_read_b128 v[64:67], v104 offset:0
    ds_read_b128 v[68:71], v104 offset:4096
    ds_read_b64_tr_b16 v[72:73], v112 offset:0
    ds_read_b64_tr_b16 v[74:75], v112 offset:256
    ds_read_b64_tr_b16 v[76:77], v113 offset:0
    ds_read_b64_tr_b16 v[78:79], v113 offset:256
    ds_read_b64_tr_b16 v[80:81], v114 offset:0
    ds_read_b64_tr_b16 v[82:83], v114 offset:256
gmix_phase1_kernel_cloop:
    s_waitcnt lgkmcnt(4)
    v_mfma_f32_32x32x16_bf16 v[160:175], v[72:75], v[64:67], v[160:175]
    ds_read_b128 v[84:87], v105 offset:0
    ds_read_b128 v[88:91], v105 offset:4096
    v_mfma_f32_32x32x16_bf16 v[208:223], v[72:75], v[68:71], v[208:223]
    ds_read_b64_tr_b16 v[92:93], v112 offset:1024
    ds_read_b64_tr_b16 v[94:95], v112 offset:1280
    s_waitcnt lgkmcnt(6)
    v_mfma_f32_32x32x16_bf16 v[176:191], v[76:79], v[64:67], v[176:191]
    ds_read_b64_tr_b16 v[96:97], v113 offset:1024
    ds_read_b64_tr_b16 v[98:99], v113 offset:1280
    v_mfma_f32_32x32x16_bf16 v[224:239], v[76:79], v[68:71], v[224:239]
    ds_read_b64_tr_b16 v[100:101], v114 offset:1024
    ds_read_b64_tr_b16 v[102:103], v114 offset:1280
    s_waitcnt lgkmcnt(8)
    v_mfma_f32_32x32x16_bf16 v[192:207], v[80:83], v[64:67], v[192:207]
    v_mfma_f32_32x32x16_bf16 v[240:255], v[80:83], v[68:71], v[240:255]
    s_waitcnt lgkmcnt(0)
    s_barrier
    s_add_u32 s96, s96, 12288
    s_cmp_eq_u32 s96, 73728
    s_cselect_b32 s96, 0, s96
    v_add_u32 v112, s96, v108
    v_add_u32 v113, s96, v109
    v_add_u32 v114, s96, v110
    v_mfma_f32_32x32x16_bf16 v[160:175], v[92:95], v[84:87], v[160:175]
    ds_read_b128 v[64:67], v106 offset:0
    ds_read_b128 v[68:71], v106 offset:4096
    v_mfma_f32_32x32x16_bf16 v[208:223], v[92:95], v[88:91], v[208:223]
    ds_read_b64_tr_b16 v[72:73], v112 offset:0
    ds_read_b64_tr_b16 v[74:75], v112 offset:256
    v_mfma_f32_32x32x16_bf16 v[176:191], v[96:99], v[84:87], v[176:191]
    ds_read_b64_tr_b16 v[76:77], v113 offset:0
    ds_read_b64_tr_b16 v[78:79], v113 offset:256
    v_mfma_f32_32x32x16_bf16 v[224:239], v[96:99], v[88:91], v[224:239]
    ds_read_b64_tr_b16 v[80:81], v114 offset:0
    ds_read_b64_tr_b16 v[82:83], v114 offset:256
    v_mfma_f32_32x32x16_bf16 v[192:207], v[100:103], v[84:87], v[192:207]
    v_mfma_f32_32x32x16_bf16 v[240:255], v[100:103], v[88:91], v[240:255]
    s_waitcnt lgkmcnt(4)
    v_mfma_f32_32x32x16_bf16 v[160:175], v[72:75], v[64:67], v[160:175]
    ds_read_b128 v[84:87], v107 offset:0
    ds_read_b128 v[88:91], v107 offset:4096
    v_mfma_f32_32x32x16_bf16 v[208:223], v[72:75], v[68:71], v[208:223]
    ds_read_b64_tr_b16 v[92:93], v112 offset:1024
    ds_read_b64_tr_b16 v[94:95], v112 offset:1280
    s_waitcnt lgkmcnt(6)
    v_mfma_f32_32x32x16_bf16 v[176:191], v[76:79], v[64:67], v[176:191]
    ds_read_b64_tr_b16 v[96:97], v113 offset:1024
    ds_read_b64_tr_b16 v[98:99], v113 offset:1280
    v_mfma_f32_32x32x16_bf16 v[224:239], v[76:79], v[68:71], v[224:239]
    ds_read_b64_tr_b16 v[100:101], v114 offset:1024
    ds_read_b64_tr_b16 v[102:103], v114 offset:1280
    s_waitcnt lgkmcnt(8)
    v_mfma_f32_32x32x16_bf16 v[192:207], v[80:83], v[64:67], v[192:207]
    v_mfma_f32_32x32x16_bf16 v[240:255], v[80:83], v[68:71], v[240:255]
    s_waitcnt lgkmcnt(0)
    s_cmp_eq_u32 s97, 7
    s_cbranch_scc1 gmix_phase1_kernel_clast
    s_barrier
    s_add_u32 s96, s96, 12288
    s_cmp_eq_u32 s96, 73728
    s_cselect_b32 s96, 0, s96
    v_add_u32 v112, s96, v108
    v_add_u32 v113, s96, v109
    v_add_u32 v114, s96, v110
    v_add_u32 v104, 16384, v104
    v_and_b32 v104, 0xffff, v104
    v_add_u32 v105, 16384, v105
    v_and_b32 v105, 0xffff, v105
    v_add_u32 v106, 16384, v106
    v_and_b32 v106, 0xffff, v106
    v_add_u32 v107, 16384, v107
    v_and_b32 v107, 0xffff, v107
    v_mfma_f32_32x32x16_bf16 v[160:175], v[92:95], v[84:87], v[160:175]
    ds_read_b128 v[64:67], v104 offset:0
    ds_read_b128 v[68:71], v104 offset:4096
    v_mfma_f32_32x32x16_bf16 v[208:223], v[92:95], v[88:91], v[208:223]
    ds_read_b64_tr_b16 v[72:73], v112 offset:0
    ds_read_b64_tr_b16 v[74:75], v112 offset:256
    v_mfma_f32_32x32x16_bf16 v[176:191], v[96:99], v[84:87], v[176:191]
    ds_read_b64_tr_b16 v[76:77], v113 offset:0
    ds_read_b64_tr_b16 v[78:79], v113 offset:256
    v_mfma_f32_32x32x16_bf16 v[224:239], v[96:99], v[88:91], v[224:239]
    ds_read_b64_tr_b16 v[80:81], v114 offset:0
    ds_read_b64_tr_b16 v[82:83], v114 offset:256
    v_mfma_f32_32x32x16_bf16 v[192:207], v[100:103], v[84:87], v[192:207]
    v_mfma_f32_32x32x16_bf16 v[240:255], v[100:103], v[88:91], v[240:255]
    s_add_u32 s97, s97, 1
    s_branch gmix_phase1_kernel_cloop
gmix_phase1_kernel_clast:
    v_mfma_f32_32x32x16_bf16 v[160:175], v[92:95], v[84:87], v[160:175]
    v_mfma_f32_32x32x16_bf16 v[208:223], v[92:95], v[88:91], v[208:223]
    v_mfma_f32_32x32x16_bf16 v[176:191], v[96:99], v[84:87], v[176:191]
    v_mfma_f32_32x32x16_bf16 v[224:239], v[96:99], v[88:91], v[224:239]
    v_mfma_f32_32x32x16_bf16 v[192:207], v[100:103], v[84:87], v[192:207]
    v_mfma_f32_32x32x16_bf16 v[240:255], v[100:103], v[88:91], v[240:255]
    s_waitcnt vmcnt(0)
    s_nop 7
    v_pk_mul_f32 v[120:121], v[160:161], v[160:161]
    v_pk_fma_f32 v[120:121], v[120:121], v[22:23], v[20:21]
    v_pk_mul_f32 v[120:121], v[120:121], v[160:161]
    v_pk_mul_f32 v[168:169], v[168:169], v[160:161]
    v_pk_mul_f32 v[122:123], v[162:163], v[162:163]
    v_pk_fma_f32 v[122:123], v[122:123], v[22:23], v[20:21]
    v_pk_mul_f32 v[122:123], v[122:123], v[162:163]
    v_pk_mul_f32 v[170:171], v[170:171], v[162:163]
    v_pk_mul_f32 v[124:125], v[164:165], v[164:165]
    v_pk_fma_f32 v[124:125], v[124:125], v[22:23], v[20:21]
    v_pk_mul_f32 v[124:125], v[124:125], v[164:165]
    v_pk_mul_f32 v[172:173], v[172:173], v[164:165]
    v_pk_mul_f32 v[126:127], v[166:167], v[166:167]
    v_pk_fma_f32 v[126:127], v[126:127], v[22:23], v[20:21]
    v_pk_mul_f32 v[126:127], v[126:127], v[166:167]
    v_pk_mul_f32 v[174:175], v[174:175], v[166:167]
    v_exp_f32 v120, v120
    v_exp_f32 v121, v121
    v_exp_f32 v122, v122
    v_exp_f32 v123, v123
    v_exp_f32 v124, v124
    v_exp_f32 v125, v125
    v_exp_f32 v126, v126
    v_exp_f32 v127, v127
    v_pk_add_f32 v[120:121], v[120:121], v[24:25]
    v_pk_add_f32 v[122:123], v[122:123], v[24:25]
    v_pk_add_f32 v[124:125], v[124:125], v[24:25]
    v_pk_add_f32 v[126:127], v[126:127], v[24:25]
    v_rcp_f32 v120, v120
    v_rcp_f32 v121, v121
    v_rcp_f32 v122, v122
    v_rcp_f32 v123, v123
    v_rcp_f32 v124, v124
    v_rcp_f32 v125, v125
    v_rcp_f32 v126, v126
    v_rcp_f32 v127, v127
    v_pk_mul_f32 v[120:121], v[120:121], v[168:169]
    v_pk_mul_f32 v[122:123], v[122:123], v[170:171]
    v_pk_mul_f32 v[124:125], v[124:125], v[172:173]
    v_pk_mul_f32 v[126:127], v[126:127], v[174:175]
    v_cvt_pk_bf16_f32 v128, v120, v121
    v_cvt_pk_bf16_f32 v129, v122, v123
    v_cvt_pk_bf16_f32 v130, v124, v125
    v_cvt_pk_bf16_f32 v131, v126, v127
    s_add_u32 s94, s13, 0
    s_add_u32 s95, s12, 0
    s_cmp_ge_u32 s94, 86
    s_cselect_b32 s95, 0x7f000000, s95
    buffer_store_dwordx4 v[128:131], v7, s[76:79], s95 offen sc1
    v_pk_mul_f32 v[132:133], v[208:209], v[208:209]
    v_pk_fma_f32 v[132:133], v[132:133], v[22:23], v[20:21]
    v_pk_mul_f32 v[132:133], v[132:133], v[208:209]
    v_pk_mul_f32 v[216:217], v[216:217], v[208:209]
    v_pk_mul_f32 v[134:135], v[210:211], v[210:211]
    v_pk_fma_f32 v[134:135], v[134:135], v[22:23], v[20:21]
    v_pk_mul_f32 v[134:135], v[134:135], v[210:211]
    v_pk_mul_f32 v[218:219], v[218:219], v[210:211]
    v_pk_mul_f32 v[136:137], v[212:213], v[212:213]
    v_pk_fma_f32 v[136:137], v[136:137], v[22:23], v[20:21]
    v_pk_mul_f32 v[136:137], v[136:137], v[212:213]
    v_pk_mul_f32 v[220:221], v[220:221], v[212:213]
    v_pk_mul_f32 v[138:139], v[214:215], v[214:215]
    v_pk_fma_f32 v[138:139], v[138:139], v[22:23], v[20:21]
    v_pk_mul_f32 v[138:139], v[138:139], v[214:215]
    v_pk_mul_f32 v[222:223], v[222:223], v[214:215]
    v_exp_f32 v132, v132
    v_exp_f32 v133, v133
    v_exp_f32 v134, v134
    v_exp_f32 v135, v135
    v_exp_f32 v136, v136
    v_exp_f32 v137, v137
    v_exp_f32 v138, v138
    v_exp_f32 v139, v139
    v_pk_add_f32 v[132:133], v[132:133], v[24:25]
    v_pk_add_f32 v[134:135], v[134:135], v[24:25]
    v_pk_add_f32 v[136:137], v[136:137], v[24:25]
    v_pk_add_f32 v[138:139], v[138:139], v[24:25]
    v_rcp_f32 v132, v132
    v_rcp_f32 v133, v133
    v_rcp_f32 v134, v134
    v_rcp_f32 v135, v135
    v_rcp_f32 v136, v136
    v_rcp_f32 v137, v137
    v_rcp_f32 v138, v138
    v_rcp_f32 v139, v139
    v_pk_mul_f32 v[132:133], v[132:133], v[216:217]
    v_pk_mul_f32 v[134:135], v[134:135], v[218:219]
    v_pk_mul_f32 v[136:137], v[136:137], v[220:221]
    v_pk_mul_f32 v[138:139], v[138:139], v[222:223]
    v_cvt_pk_bf16_f32 v140, v132, v133
    v_cvt_pk_bf16_f32 v141, v134, v135
    v_cvt_pk_bf16_f32 v142, v136, v137
    v_cvt_pk_bf16_f32 v143, v138, v139
    s_add_u32 s94, s13, 0
    s_add_u32 s95, s12, 88064
    s_cmp_ge_u32 s94, 86
    s_cselect_b32 s95, 0x7f000000, s95
    buffer_store_dwordx4 v[140:143], v7, s[76:79], s95 offen sc1
    v_pk_mul_f32 v[120:121], v[176:177], v[176:177]
    v_pk_fma_f32 v[120:121], v[120:121], v[22:23], v[20:21]
    v_pk_mul_f32 v[120:121], v[120:121], v[176:177]
    v_pk_mul_f32 v[184:185], v[184:185], v[176:177]
    v_pk_mul_f32 v[122:123], v[178:179], v[178:179]
    v_pk_fma_f32 v[122:123], v[122:123], v[22:23], v[20:21]
    v_pk_mul_f32 v[122:123], v[122:123], v[178:179]
    v_pk_mul_f32 v[186:187], v[186:187], v[178:179]
    v_pk_mul_f32 v[124:125], v[180:181], v[180:181]
    v_pk_fma_f32 v[124:125], v[124:125], v[22:23], v[20:21]
    v_pk_mul_f32 v[124:125], v[124:125], v[180:181]
    v_pk_mul_f32 v[188:189], v[188:189], v[180:181]
    v_pk_mul_f32 v[126:127], v[182:183], v[182:183]
    v_pk_fma_f32 v[126:127], v[126:127], v[22:23], v[20:21]
    v_pk_mul_f32 v[126:127], v[126:127], v[182:183]
    v_pk_mul_f32 v[190:191], v[190:191], v[182:183]
    v_exp_f32 v120, v120
    v_exp_f32 v121, v121
    v_exp_f32 v122, v122
    v_exp_f32 v123, v123
    v_exp_f32 v124, v124
    v_exp_f32 v125, v125
    v_exp_f32 v126, v126
    v_exp_f32 v127, v127
    v_pk_add_f32 v[120:121], v[120:121], v[24:25]
    v_pk_add_f32 v[122:123], v[122:123], v[24:25]
    v_pk_add_f32 v[124:125], v[124:125], v[24:25]
    v_pk_add_f32 v[126:127], v[126:127], v[24:25]
    v_rcp_f32 v120, v120
    v_rcp_f32 v121, v121
    v_rcp_f32 v122, v122
    v_rcp_f32 v123, v123
    v_rcp_f32 v124, v124
    v_rcp_f32 v125, v125
    v_rcp_f32 v126, v126
    v_rcp_f32 v127, v127
    v_pk_mul_f32 v[120:121], v[120:121], v[184:185]
    v_pk_mul_f32 v[122:123], v[122:123], v[186:187]
    v_pk_mul_f32 v[124:125], v[124:125], v[188:189]
    v_pk_mul_f32 v[126:127], v[126:127], v[190:191]
    v_cvt_pk_bf16_f32 v128, v120, v121
    v_cvt_pk_bf16_f32 v129, v122, v123
    v_cvt_pk_bf16_f32 v130, v124, v125
    v_cvt_pk_bf16_f32 v131, v126, v127
    s_add_u32 s94, s13, 1
    s_add_u32 s95, s12, 1024
    s_cmp_ge_u32 s94, 86
    s_cselect_b32 s95, 0x7f000000, s95
    buffer_store_dwordx4 v[128:131], v7, s[76:79], s95 offen sc1
    v_pk_mul_f32 v[132:133], v[224:225], v[224:225]
    v_pk_fma_f32 v[132:133], v[132:133], v[22:23], v[20:21]
    v_pk_mul_f32 v[132:133], v[132:133], v[224:225]
    v_pk_mul_f32 v[232:233], v[232:233], v[224:225]
    v_pk_mul_f32 v[134:135], v[226:227], v[226:227]
    v_pk_fma_f32 v[134:135], v[134:135], v[22:23], v[20:21]
    v_pk_mul_f32 v[134:135], v[134:135], v[226:227]
    v_pk_mul_f32 v[234:235], v[234:235], v[226:227]
    v_pk_mul_f32 v[136:137], v[228:229], v[228:229]
    v_pk_fma_f32 v[136:137], v[136:137], v[22:23], v[20:21]
    v_pk_mul_f32 v[136:137], v[136:137], v[228:229]
    v_pk_mul_f32 v[236:237], v[236:237], v[228:229]
    v_pk_mul_f32 v[138:139], v[230:231], v[230:231]
    v_pk_fma_f32 v[138:139], v[138:139], v[22:23], v[20:21]
    v_pk_mul_f32 v[138:139], v[138:139], v[230:231]
    v_pk_mul_f32 v[238:239], v[238:239], v[230:231]
    v_exp_f32 v132, v132
    v_exp_f32 v133, v133
    v_exp_f32 v134, v134
    v_exp_f32 v135, v135
    v_exp_f32 v136, v136
    v_exp_f32 v137, v137
    v_exp_f32 v138, v138
    v_exp_f32 v139, v139
    v_pk_add_f32 v[132:133], v[132:133], v[24:25]
    v_pk_add_f32 v[134:135], v[134:135], v[24:25]
    v_pk_add_f32 v[136:137], v[136:137], v[24:25]
    v_pk_add_f32 v[138:139], v[138:139], v[24:25]
    v_rcp_f32 v132, v132
    v_rcp_f32 v133, v133
    v_rcp_f32 v134, v134
    v_rcp_f32 v135, v135
    v_rcp_f32 v136, v136
    v_rcp_f32 v137, v137
    v_rcp_f32 v138, v138
    v_rcp_f32 v139, v139
    v_pk_mul_f32 v[132:133], v[132:133], v[232:233]
    v_pk_mul_f32 v[134:135], v[134:135], v[234:235]
    v_pk_mul_f32 v[136:137], v[136:137], v[236:237]
    v_pk_mul_f32 v[138:139], v[138:139], v[238:239]
    v_cvt_pk_bf16_f32 v140, v132, v133
    v_cvt_pk_bf16_f32 v141, v134, v135
    v_cvt_pk_bf16_f32 v142, v136, v137
    v_cvt_pk_bf16_f32 v143, v138, v139
    s_add_u32 s94, s13, 1
    s_add_u32 s95, s12, 89088
    s_cmp_ge_u32 s94, 86
    s_cselect_b32 s95, 0x7f000000, s95
    buffer_store_dwordx4 v[140:143], v7, s[76:79], s95 offen sc1
    v_pk_mul_f32 v[120:121], v[192:193], v[192:193]
    v_pk_fma_f32 v[120:121], v[120:121], v[22:23], v[20:21]
    v_pk_mul_f32 v[120:121], v[120:121], v[192:193]
    v_pk_mul_f32 v[200:201], v[200:201], v[192:193]
    v_pk_mul_f32 v[122:123], v[194:195], v[194:195]
    v_pk_fma_f32 v[122:123], v[122:123], v[22:23], v[20:21]
    v_pk_mul_f32 v[122:123], v[122:123], v[194:195]
    v_pk_mul_f32 v[202:203], v[202:203], v[194:195]
    v_pk_mul_f32 v[124:125], v[196:197], v[196:197]
    v_pk_fma_f32 v[124:125], v[124:125], v[22:23], v[20:21]
    v_pk_mul_f32 v[124:125], v[124:125], v[196:197]
    v_pk_mul_f32 v[204:205], v[204:205], v[196:197]
    v_pk_mul_f32 v[126:127], v[198:199], v[198:199]
    v_pk_fma_f32 v[126:127], v[126:127], v[22:23], v[20:21]
    v_pk_mul_f32 v[126:127], v[126:127], v[198:199]
    v_pk_mul_f32 v[206:207], v[206:207], v[198:199]
    v_exp_f32 v120, v120
    v_exp_f32 v121, v121
    v_exp_f32 v122, v122
    v_exp_f32 v123, v123
    v_exp_f32 v124, v124
    v_exp_f32 v125, v125
    v_exp_f32 v126, v126
    v_exp_f32 v127, v127
    v_pk_add_f32 v[120:121], v[120:121], v[24:25]
    v_pk_add_f32 v[122:123], v[122:123], v[24:25]
    v_pk_add_f32 v[124:125], v[124:125], v[24:25]
    v_pk_add_f32 v[126:127], v[126:127], v[24:25]
    v_rcp_f32 v120, v120
    v_rcp_f32 v121, v121
    v_rcp_f32 v122, v122
    v_rcp_f32 v123, v123
    v_rcp_f32 v124, v124
    v_rcp_f32 v125, v125
    v_rcp_f32 v126, v126
    v_rcp_f32 v127, v127
    v_pk_mul_f32 v[120:121], v[120:121], v[200:201]
    v_pk_mul_f32 v[122:123], v[122:123], v[202:203]
    v_pk_mul_f32 v[124:125], v[124:125], v[204:205]
    v_pk_mul_f32 v[126:127], v[126:127], v[206:207]
    v_cvt_pk_bf16_f32 v128, v120, v121
    v_cvt_pk_bf16_f32 v129, v122, v123
    v_cvt_pk_bf16_f32 v130, v124, v125
    v_cvt_pk_bf16_f32 v131, v126, v127
    s_add_u32 s94, s13, 2
    s_add_u32 s95, s12, 2048
    s_cmp_ge_u32 s94, 86
    s_cselect_b32 s95, 0x7f000000, s95
    buffer_store_dwordx4 v[128:131], v7, s[76:79], s95 offen sc1
    v_pk_mul_f32 v[132:133], v[240:241], v[240:241]
    v_pk_fma_f32 v[132:133], v[132:133], v[22:23], v[20:21]
    v_pk_mul_f32 v[132:133], v[132:133], v[240:241]
    v_pk_mul_f32 v[248:249], v[248:249], v[240:241]
    v_pk_mul_f32 v[134:135], v[242:243], v[242:243]
    v_pk_fma_f32 v[134:135], v[134:135], v[22:23], v[20:21]
    v_pk_mul_f32 v[134:135], v[134:135], v[242:243]
    v_pk_mul_f32 v[250:251], v[250:251], v[242:243]
    v_pk_mul_f32 v[136:137], v[244:245], v[244:245]
    v_pk_fma_f32 v[136:137], v[136:137], v[22:23], v[20:21]
    v_pk_mul_f32 v[136:137], v[136:137], v[244:245]
    v_pk_mul_f32 v[252:253], v[252:253], v[244:245]
    v_pk_mul_f32 v[138:139], v[246:247], v[246:247]
    v_pk_fma_f32 v[138:139], v[138:139], v[22:23], v[20:21]
    v_pk_mul_f32 v[138:139], v[138:139], v[246:247]
    v_pk_mul_f32 v[254:255], v[254:255], v[246:247]
    v_exp_f32 v132, v132
    v_exp_f32 v133, v133
    v_exp_f32 v134, v134
    v_exp_f32 v135, v135
    v_exp_f32 v136, v136
    v_exp_f32 v137, v137
    v_exp_f32 v138, v138
    v_exp_f32 v139, v139
    v_pk_add_f32 v[132:133], v[132:133], v[24:25]
    v_pk_add_f32 v[134:135], v[134:135], v[24:25]
    v_pk_add_f32 v[136:137], v[136:137], v[24:25]
    v_pk_add_f32 v[138:139], v[138:139], v[24:25]
    v_rcp_f32 v132, v132
    v_rcp_f32 v133, v133
    v_rcp_f32 v134, v134
    v_rcp_f32 v135, v135
    v_rcp_f32 v136, v136
    v_rcp_f32 v137, v137
    v_rcp_f32 v138, v138
    v_rcp_f32 v139, v139
    v_pk_mul_f32 v[132:133], v[132:133], v[248:249]
    v_pk_mul_f32 v[134:135], v[134:135], v[250:251]
    v_pk_mul_f32 v[136:137], v[136:137], v[252:253]
    v_pk_mul_f32 v[138:139], v[138:139], v[254:255]
    v_cvt_pk_bf16_f32 v140, v132, v133
    v_cvt_pk_bf16_f32 v141, v134, v135
    v_cvt_pk_bf16_f32 v142, v136, v137
    v_cvt_pk_bf16_f32 v143, v138, v139
    s_add_u32 s94, s13, 2
    s_add_u32 s95, s12, 90112
    s_cmp_ge_u32 s94, 86
    s_cselect_b32 s95, 0x7f000000, s95
    buffer_store_dwordx4 v[140:143], v7, s[76:79], s95 offen sc1
    s_endpgm
gmix_phase1_kernel_helper:
    v_and_b32 v14, 7, v1
    v_lshrrev_b32 v15, 4, v1
    v_xor_b32 v14, v14, v15
    v_lshlrev_b32 v14, 4, v14
    v_lshrrev_b32 v15, 3, v1
    v_lshl_add_u32 v10, v15, 10, v14
    v_xor_b32 v11, 64, v10
    v_add_u32 v11, 8192, v11
    s_lshl_b32 s10, s9, 1
    v_xor_b32 v14, s10, v3
    v_mul_u32_u24 v12, 2752, v2
    v_lshl_add_u32 v12, v14, 4, v12
    s_lshl_b32 s96, s6, 17
    s_lshl_b32 s94, s3, 15
    s_add_u32 s96, s96, s94
    s_add_u32 s98, s96, 16384
    s_mul_i32 s97, s11, 44032
    s_mul_i32 s94, s7, 192
    s_add_u32 s97, s97, s94
    s_lshl_b32 s99, s3, 12
    s_mul_i32 s100, s9, 6144
    s_lshl_b32 s94, s11, 10
    s_add_u32 s100, s100, s94
    s_add_u32 s100, s100, 65536
    s_lshr_b32 s85, s5, 3
    s_lshl_b32 s85, s85, 1
    s_add_u32 s84, s5, s85
    s_and_b32 s84, s84, 7
    s_lshl_b32 s91, s84, 1
    s_lshl_b32 s84, s84, 7
    s_mov_b32 s85, s84
    s_cmp_eq_u32 s7, 15
    s_cselect_b32 s96, 0x7f000000, s96
    s_cselect_b32 s98, 0x7f000000, s98
    s_cselect_b32 s97, 0x7f000000, s97
    s_cmp_eq_u32 s9, 0
    s_waitcnt lgkmcnt(0)
    s_cselect_b32 s64, s30, s32
    s_cselect_b32 s65, s31, s33
    s_mov_b32 s66, 1409024
    s_mov_b32 s67, 0x00020000
    s_mov_b32 s44, s16
    s_mov_b32 s45, s17
    s_mov_b32 s46, 2097152
    s_mov_b32 s47, 0x00020000
    s_add_u32 m0, s99, 0
    s_add_u32 s83, s96, s84
    buffer_load_dwordx4 v10, s[44:47], s83 offen lds
    s_add_u32 m0, s99, 1024
    s_add_u32 s83, s96, s84
    buffer_load_dwordx4 v11, s[44:47], s83 offen lds
    s_add_u32 s84, s84, 128
    s_and_b32 s84, s84, 1023
    s_add_u32 m0, s99, 2048
    s_add_u32 s83, s98, s85
    buffer_load_dwordx4 v10, s[44:47], s83 offen lds
    s_add_u32 m0, s99, 3072
    s_add_u32 s83, s98, s85
    buffer_load_dwordx4 v11, s[44:47], s83 offen lds
    s_add_u32 s85, s85, 128
    s_and_b32 s85, s85, 1023
    s_mul_i32 s82, s91, 88064
    s_add_u32 s82, s82, s97
    s_add_u32 m0, s100, 0
    s_nop 0
    buffer_load_dwordx4 v12, s[64:67], s82 offen offset:0 lds
    s_add_u32 m0, s100, 1984
    s_nop 0
    buffer_load_dwordx4 v12, s[64:67], s82 offen offset:64 lds
    s_add_u32 m0, s100, 3968
    s_nop 0
    buffer_load_dwordx4 v12, s[64:67], s82 offen offset:128 lds
    s_add_u32 s91, s91, 1
    s_and_b32 s91, s91, 15
    s_mul_i32 s82, s91, 88064
    s_add_u32 s82, s82, s97
    s_add_u32 m0, s100, 12288
    s_nop 0
    buffer_load_dwordx4 v12, s[64:67], s82 offen offset:0 lds
    s_add_u32 m0, s100, 14272
    s_nop 0
    buffer_load_dwordx4 v12, s[64:67], s82 offen offset:64 lds
    s_add_u32 m0, s100, 16256
    s_nop 0
    buffer_load_dwordx4 v12, s[64:67], s82 offen offset:128 lds
    s_add_u32 s91, s91, 1
    s_and_b32 s91, s91, 15
    s_mov_b32 s48, s18
    s_mov_b32 s49, s19
    s_mov_b32 s50, 2097152
    s_mov_b32 s51, 0x00020000
    s_mov_b32 s52, s20
    s_mov_b32 s53, s21
    s_mov_b32 s54, 2097152
    s_mov_b32 s55, 0x00020000
    s_mov_b32 s56, s22
    s_mov_b32 s57, s23
    s_mov_b32 s58, 4096
    s_mov_b32 s59, 0x00020000
    s_mov_b32 s60, s24
    s_mov_b32 s61, s25
    s_mov_b32 s62, 2097152
    s_mov_b32 s63, 0x00020000
    s_mov_b32 s68, s34
    s_mov_b32 s69, s35
    s_mov_b32 s70, 1409024
    s_mov_b32 s71, 0x00020000
    s_mov_b32 s72, s36
    s_mov_b32 s73, s37
    s_mov_b32 s74, 1024
    s_mov_b32 s75, 0x00020000
    s_mov_b32 s76, s42
    s_mov_b32 s77, s43
    s_mov_b32 s78, 16777216
    s_mov_b32 s79, 0x00020000
    s_add_u32 m0, s99, 16384
    s_add_u32 s83, s96, s84
    buffer_load_dwordx4 v10, s[44:47], s83 offen lds
    s_add_u32 m0, s99, 17408
    s_add_u32 s83, s96, s84
    buffer_load_dwordx4 v11, s[44:47], s83 offen lds
    s_add_u32 s84, s84, 128
    s_and_b32 s84, s84, 1023
    s_add_u32 m0, s99, 18432
    s_add_u32 s83, s98, s85
    buffer_load_dwordx4 v10, s[44:47], s83 offen lds
    s_add_u32 m0, s99, 19456
    s_add_u32 s83, s98, s85
    buffer_load_dwordx4 v11, s[44:47], s83 offen lds
    s_add_u32 s85, s85, 128
    s_and_b32 s85, s85, 1023
    v_lshrrev_b32 v13, 1, v3
    s_lshl_b32 s94, s3, 1
    v_add_u32 v13, s94, v13
    v_and_b32 v14, 1, v3
    v_lshlrev_b32 v14, 3, v14
    v_lshl_add_u32 v14, v2, 9, v14
    v_add_u32 v14, 139264, v14
    v_add_u32 v15, 0, v2
    v_and_b32 v15, 7, v15
    v_xor_b32 v15, v15, v13
    v_lshl_add_u32 v4, v15, 4, v14
    v_add_u32 v15, 1, v2
    v_and_b32 v15, 7, v15
    v_xor_b32 v15, v15, v13
    v_lshl_add_u32 v5, v15, 4, v14
    v_add_u32 v15, 2, v2
    v_and_b32 v15, 7, v15
    v_xor_b32 v15, v15, v13
    v_lshl_add_u32 v6, v15, 4, v14
    s_waitcnt vmcnt(7)
    s_barrier
    s_mul_i32 s82, s91, 88064
    s_add_u32 s82, s82, s97
    s_add_u32 m0, s100, 24576
    s_nop 0
    buffer_load_dwordx4 v12, s[64:67], s82 offen offset:0 lds
    s_add_u32 m0, s100, 26560
    s_nop 0
    buffer_load_dwordx4 v12, s[64:67], s82 offen offset:64 lds
    s_add_u32 m0, s100, 28544
    s_nop 0
    buffer_load_dwordx4 v12, s[64:67], s82 offen offset:128 lds
    s_add_u32 s91, s91, 1
    s_and_b32 s91, s91, 15
    s_add_u32 m0, s99, 32768
    s_add_u32 s83, s96, s84
    buffer_load_dwordx4 v10, s[44:47], s83 offen lds
    s_add_u32 m0, s99, 33792
    s_add_u32 s83, s96, s84
    buffer_load_dwordx4 v11, s[44:47], s83 offen lds
    s_add_u32 s84, s84, 128
    s_and_b32 s84, s84, 1023
    s_mul_i32 s82, s91, 88064
    s_add_u32 s82, s82, s97
    s_add_u32 m0, s100, 36864
    s_nop 0
    buffer_load_dwordx4 v12, s[64:67], s82 offen offset:0 lds
    s_add_u32 m0, s100, 38848
    s_nop 0
    buffer_load_dwordx4 v12, s[64:67], s82 offen offset:64 lds
    s_add_u32 m0, s100, 40832
    s_nop 0
    buffer_load_dwordx4 v12, s[64:67], s82 offen offset:128 lds
    s_add_u32 s91, s91, 1
    s_and_b32 s91, s91, 15
    s_add_u32 m0, s99, 34816
    s_add_u32 s83, s98, s85
    buffer_load_dwordx4 v10, s[44:47], s83 offen lds
    s_add_u32 m0, s99, 35840
    s_add_u32 s83, s98, s85
    buffer_load_dwordx4 v11, s[44:47], s83 offen lds
    s_add_u32 s85, s85, 128
    s_and_b32 s85, s85, 1023
    s_and_b32 s10, s4, 1
    s_lshl_b32 s10, s10, 10
    s_lshr_b32 s94, s4, 1
    s_lshl_b32 s94, s94, 8
    s_add_u32 s10, s10, s94
    s_lshl_b32 s94, s5, 3
    s_add_u32 s10, s10, s94
    s_lshl_b32 s94, s3, 1
    s_add_u32 s10, s10, s94
    s_lshl_b32 s94, s10, 10
    buffer_load_dwordx4 v[48:51], v7, s[44:47], s94 offen
    buffer_load_dwordx4 v[52:55], v7, s[44:47], s94 offen offset:1024
    buffer_load_dwordx4 v[56:59], v7, s[72:75], 0 offen
    s_waitcnt vmcnt(17)
    s_barrier
    s_mul_i32 s82, s91, 88064
    s_add_u32 s82, s82, s97
    s_add_u32 m0, s100, 49152
    s_nop 0
    buffer_load_dwordx4 v12, s[64:67], s82 offen offset:0 lds
    s_add_u32 m0, s100, 51136
    s_nop 0
    buffer_load_dwordx4 v12, s[64:67], s82 offen offset:64 lds
    s_add_u32 m0, s100, 53120
    s_nop 0
    buffer_load_dwordx4 v12, s[64:67], s82 offen offset:128 lds
    s_add_u32 s91, s91, 1
    s_and_b32 s91, s91, 15
    s_add_u32 m0, s99, 49152
    s_add_u32 s83, s96, s84
    buffer_load_dwordx4 v10, s[44:47], s83 offen lds
    s_add_u32 m0, s99, 50176
    s_add_u32 s83, s96, s84
    buffer_load_dwordx4 v11, s[44:47], s83 offen lds
    s_add_u32 s84, s84, 128
    s_and_b32 s84, s84, 1023
    s_waitcnt vmcnt(15)
    s_barrier
    s_mul_i32 s82, s91, 88064
    s_add_u32 s82, s82, s97
    s_add_u32 m0, s100, 61440
    s_nop 0
    buffer_load_dwordx4 v12, s[64:67], s82 offen offset:0 lds
    s_add_u32 m0, s100, 63424
    s_nop 0
    buffer_load_dwordx4 v12, s[64:67], s82 offen offset:64 lds
    s_add_u32 m0, s100, 65408
    s_nop 0
    buffer_load_dwordx4 v12, s[64:67], s82 offen offset:128 lds
    s_add_u32 s91, s91, 1
    s_and_b32 s91, s91, 15
    s_add_u32 m0, s99, 51200
    s_add_u32 s83, s98, s85
    buffer_load_dwordx4 v10, s[44:47], s83 offen lds
    s_add_u32 m0, s99, 52224
    s_add_u32 s83, s98, s85
    buffer_load_dwordx4 v11, s[44:47], s83 offen lds
    s_add_u32 s85, s85, 128
    s_and_b32 s85, s85, 1023
    s_waitcnt vmcnt(10)
    v_lshlrev_b32 v180, 16, v56
    v_and_b32 v181, 0xffff0000, v56
    v_lshlrev_b32 v182, 16, v57
    v_and_b32 v183, 0xffff0000, v57
    v_lshlrev_b32 v184, 16, v58
    v_and_b32 v185, 0xffff0000, v58
    v_lshlrev_b32 v186, 16, v59
    v_and_b32 v187, 0xffff0000, v59
    v_lshlrev_b32 v24, 16, v48
    v_and_b32 v25, 0xffff0000, v48
    v_mul_f32 v24, v24, v180
    v_mul_f32 v25, v25, v181
    v_cvt_pk_bf16_f32 v24, v24, v25
    v_and_b32 v25, 0xffff0000, v24
    v_lshlrev_b32 v24, 16, v24
    v_add_f32 v28, v24, v25
    v_lshlrev_b32 v24, 16, v49
    v_and_b32 v25, 0xffff0000, v49
    v_mul_f32 v24, v24, v182
    v_mul_f32 v25, v25, v183
    v_cvt_pk_bf16_f32 v24, v24, v25
    v_and_b32 v25, 0xffff0000, v24
    v_lshlrev_b32 v24, 16, v24
    v_add_f32 v24, v24, v25
    v_add_f32 v28, v28, v24
    v_lshlrev_b32 v24, 16, v50
    v_and_b32 v25, 0xffff0000, v50
    v_mul_f32 v24, v24, v184
    v_mul_f32 v25, v25, v185
    v_cvt_pk_bf16_f32 v24, v24, v25
    v_and_b32 v25, 0xffff0000, v24
    v_lshlrev_b32 v24, 16, v24
    s_barrier
    s_mul_i32 s82, s91, 88064
    s_add_u32 s82, s82, s97
    s_add_u32 m0, s100, 0
    s_nop 0
    buffer_load_dwordx4 v12, s[64:67], s82 offen offset:0 lds
    s_add_u32 m0, s100, 1984
    s_nop 0
    buffer_load_dwordx4 v12, s[64:67], s82 offen offset:64 lds
    s_add_u32 m0, s100, 3968
    s_nop 0
    buffer_load_dwordx4 v12, s[64:67], s82 offen offset:128 lds
    s_add_u32 s91, s91, 1
    s_and_b32 s91, s91, 15
    s_add_u32 m0, s99, 0
    s_add_u32 s83, s96, s84
    buffer_load_dwordx4 v10, s[44:47], s83 offen lds
    s_add_u32 m0, s99, 1024
    s_add_u32 s83, s96, s84
    buffer_load_dwordx4 v11, s[44:47], s83 offen lds
    s_add_u32 s84, s84, 128
    s_and_b32 s84, s84, 1023
    s_mul_i32 s82, s91, 88064
    s_add_u32 s82, s82, s97
    s_add_u32 m0, s100, 12288
    s_nop 0
    buffer_load_dwordx4 v12, s[64:67], s82 offen offset:0 lds
    s_add_u32 m0, s100, 14272
    s_nop 0
    buffer_load_dwordx4 v12, s[64:67], s82 offen offset:64 lds
    s_add_u32 m0, s100, 16256
    s_nop 0
    buffer_load_dwordx4 v12, s[64:67], s82 offen offset:128 lds
    s_add_u32 s91, s91, 1
    s_and_b32 s91, s91, 15
    s_add_u32 m0, s99, 2048
    s_add_u32 s83, s98, s85
    buffer_load_dwordx4 v10, s[44:47], s83 offen lds
    s_add_u32 m0, s99, 3072
    s_add_u32 s83, s98, s85
    buffer_load_dwordx4 v11, s[44:47], s83 offen lds
    s_add_u32 s85, s85, 128
    s_and_b32 s85, s85, 1023
    v_add_f32 v24, v24, v25
    v_add_f32 v28, v28, v24
    v_lshlrev_b32 v24, 16, v51
    v_and_b32 v25, 0xffff0000, v51
    v_mul_f32 v24, v24, v186
    v_mul_f32 v25, v25, v187
    v_cvt_pk_bf16_f32 v24, v24, v25
    v_and_b32 v25, 0xffff0000, v24
    v_lshlrev_b32 v24, 16, v24
    v_add_f32 v24, v24, v25
    v_add_f32 v28, v28, v24
    v_lshlrev_b32 v24, 16, v52
    v_and_b32 v25, 0xffff0000, v52
    v_mul_f32 v24, v24, v180
    v_mul_f32 v25, v25, v181
    v_cvt_pk_bf16_f32 v24, v24, v25
    v_and_b32 v25, 0xffff0000, v24
    v_lshlrev_b32 v24, 16, v24
    v_add_f32 v29, v24, v25
    v_lshlrev_b32 v24, 16, v53
    v_and_b32 v25, 0xffff0000, v53
    v_mul_f32 v24, v24, v182
    v_mul_f32 v25, v25, v183
    v_cvt_pk_bf16_f32 v24, v24, v25
    v_and_b32 v25, 0xffff0000, v24
    v_lshlrev_b32 v24, 16, v24
    v_add_f32 v24, v24, v25
    v_add_f32 v29, v29, v24
    v_lshlrev_b32 v24, 16, v54
    v_and_b32 v25, 0xffff0000, v54
    v_mul_f32 v24, v24, v184
    s_waitcnt vmcnt(17)
    s_barrier
    s_mul_i32 s82, s91, 88064
    s_add_u32 s82, s82, s97
    s_add_u32 m0, s100, 24576
    s_nop 0
    buffer_load_dwordx4 v12, s[64:67], s82 offen offset:0 lds
    s_add_u32 m0, s100, 26560
    s_nop 0
    buffer_load_dwordx4 v12, s[64:67], s82 offen offset:64 lds
    s_add_u32 m0, s100, 28544
    s_nop 0
    buffer_load_dwordx4 v12, s[64:67], s82 offen offset:128 lds
    s_add_u32 s91, s91, 1
    s_and_b32 s91, s91, 15
    s_add_u32 m0, s99, 16384
    s_add_u32 s83, s96, s84
    buffer_load_dwordx4 v10, s[44:47], s83 offen lds
    s_add_u32 m0, s99, 17408
    s_add_u32 s83, s96, s84
    buffer_load_dwordx4 v11, s[44:47], s83 offen lds
    s_add_u32 s84, s84, 128
    s_and_b32 s84, s84, 1023
    v_mul_f32 v25, v25, v185
    v_cvt_pk_bf16_f32 v24, v24, v25
    v_and_b32 v25, 0xffff0000, v24
    v_lshlrev_b32 v24, 16, v24
    v_add_f32 v24, v24, v25
    v_add_f32 v29, v29, v24
    v_lshlrev_b32 v24, 16, v55
    v_and_b32 v25, 0xffff0000, v55
    v_mul_f32 v24, v24, v186
    v_mul_f32 v25, v25, v187
    v_cvt_pk_bf16_f32 v24, v24, v25
    v_and_b32 v25, 0xffff0000, v24
    v_lshlrev_b32 v24, 16, v24
    v_add_f32 v24, v24, v25
    v_add_f32 v29, v29, v24
    s_nop 1
    v_add_f32_dpp v28, v28, v28 row_shr:1 bound_ctrl:0
    v_add_f32_dpp v29, v29, v29 row_shr:1 bound_ctrl:0
    s_nop 1
    v_add_f32_dpp v28, v28, v28 row_shr:2 bound_ctrl:0
    v_add_f32_dpp v29, v29, v29 row_shr:2 bound_ctrl:0
    s_nop 1
    v_add_f32_dpp v28, v28, v28 row_shr:4 bound_ctrl:0
    v_add_f32_dpp v29, v29, v29 row_shr:4 bound_ctrl:0
    s_nop 1
    v_add_f32_dpp v28, v28, v28 row_shr:8 bound_ctrl:0
    v_add_f32_dpp v29, v29, v29 row_shr:8 bound_ctrl:0
    s_nop 1
    v_add_f32_dpp v28, v28, v28 row_bcast:15 row_mask:0xa
    v_add_f32_dpp v29, v29, v29 row_bcast:15 row_mask:0xa
    s_nop 1
    v_add_f32_dpp v28, v28, v28 row_bcast:31 row_mask:0xc
    s_waitcnt vmcnt(17)
    s_barrier
    s_mul_i32 s82, s91, 88064
    s_add_u32 s82, s82, s97
    s_add_u32 m0, s100, 36864
    s_nop 0
    buffer_load_dwordx4 v12, s[64:67], s82 offen offset:0 lds
    s_add_u32 m0, s100, 38848
    s_nop 0
    buffer_load_dwordx4 v12, s[64:67], s82 offen offset:64 lds
    s_add_u32 m0, s100, 40832
    s_nop 0
    buffer_load_dwordx4 v12, s[64:67], s82 offen offset:128 lds
    s_add_u32 s91, s91, 1
    s_and_b32 s91, s91, 15
    s_add_u32 m0, s99, 18432
    s_add_u32 s83, s98, s85
    buffer_load_dwordx4 v10, s[44:47], s83 offen lds
    s_add_u32 m0, s99, 19456
    s_add_u32 s83, s98, s85
    buffer_load_dwordx4 v11, s[44:47], s83 offen lds
    s_add_u32 s85, s85, 128
    s_and_b32 s85, s85, 1023
    s_mul_i32 s82, s91, 88064
    s_add_u32 s82, s82, s97
    s_add_u32 m0, s100, 49152
    s_nop 0
    buffer_load_dwordx4 v12, s[64:67], s82 offen offset:0 lds
    s_add_u32 m0, s100, 51136
    s_nop 0
    buffer_load_dwordx4 v12, s[64:67], s82 offen offset:64 lds
    s_add_u32 m0, s100, 53120
    s_nop 0
    buffer_load_dwordx4 v12, s[64:67], s82 offen offset:128 lds
    s_add_u32 s91, s91, 1
    s_and_b32 s91, s91, 15
    v_add_f32_dpp v29, v29, v29 row_bcast:31 row_mask:0xc
    v_cvt_pk_bf16_f32 v28, v28, v29
    v_and_b32 v29, 0xffff0000, v28
    v_lshlrev_b32 v28, 16, v28
    v_mul_f32 v28, 0xbfb8aa3b, v28
    v_mul_f32 v29, 0xbfb8aa3b, v29
    v_exp_f32 v28, v28
    v_exp_f32 v29, v29
    s_nop 0
    v_add_f32 v28, 1.0, v28
    v_add_f32 v29, 1.0, v29
    v_rcp_f32 v28, v28
    v_rcp_f32 v29, v29
    s_nop 0
    v_cvt_pk_bf16_f32 v28, v28, v29
    v_and_b32 v29, 0xffff0000, v28
    v_lshlrev_b32 v28, 16, v28
    v_cmp_eq_u32 vcc, 63, v1
    s_lshl_b32 s94, s10, 2
    s_add_u32 s94, s94, 4194304
    v_mov_b32 v24, 0x7f000000
    v_mov_b32 v25, s94
    v_cndmask_b32 v24, v24, v25, vcc
    buffer_store_dwordx2 v[28:29], v24, s[76:79], 0 offen
    s_lshl_b32 s94, s2, 7
    s_add_u32 s94, s94, 4259840
    v_lshlrev_b32 v24, 2, v1
    v_mov_b32 v25, 0
    s_mov_b32 exec_hi, 0
    buffer_store_dword v25, v24, s[76:79], s94 offen
    s_mov_b32 exec_hi, -1
    s_waitcnt vmcnt(22)
    s_barrier
    s_mul_i32 s82, s91, 88064
    s_add_u32 s82, s82, s97
    s_add_u32 m0, s100, 61440
    s_nop 0
    buffer_load_dwordx4 v12, s[64:67], s82 offen offset:0 lds
    s_add_u32 m0, s100, 63424
    s_nop 0
    buffer_load_dwordx4 v12, s[64:67], s82 offen offset:64 lds
    s_add_u32 m0, s100, 65408
    s_nop 0
    buffer_load_dwordx4 v12, s[64:67], s82 offen offset:128 lds
    s_add_u32 s91, s91, 1
    s_and_b32 s91, s91, 15
    s_add_u32 m0, s99, 32768
    s_add_u32 s83, s96, s84
    buffer_load_dwordx4 v10, s[44:47], s83 offen lds
    s_add_u32 m0, s99, 33792
    s_add_u32 s83, s96, s84
    buffer_load_dwordx4 v11, s[44:47], s83 offen lds
    s_add_u32 s84, s84, 128
    s_and_b32 s84, s84, 1023
    s_lshl_b32 s12, s4, 2
    s_lshr_b32 s94, s5, 3
    s_add_u32 s12, s12, s94
    s_and_b32 s13, s5, 7
    s_lshl_b32 s13, s13, 7
    s_lshl_b32 s94, s3, 5
    s_add_u32 s13, s13, s94
    s_lshl_b32 s94, s13, 2
    v_lshlrev_b32 v64, 5, v3
    v_add_u32 v64, s94, v64
    buffer_load_dwordx4 v[38:41], v64, s[56:59], 0 offen
    buffer_load_dwordx4 v[42:45], v64, s[56:59], 0 offen offset:16
    s_lshl_b32 s8, s4, 2
    s_lshr_b32 s94, s5, 3
    s_add_u32 s8, s8, s94
    s_lshl_b32 s8, s8, 16
    s_and_b32 s94, s5, 7
    s_lshl_b32 s94, s94, 7
    s_add_u32 s8, s8, s94
    s_lshl_b32 s94, s3, 13
    s_add_u32 s8, s8, s94
    v_lshrrev_b32 v63, 5, v1
    s_lshl_b32 s94, s3, 1
    v_add_u32 v63, s94, v63
    v_and_b32 v62, 7, v1
    v_xor_b32 v63, v63, v62
    v_lshlrev_b32 v63, 4, v63
    v_lshrrev_b32 v62, 3, v1
    v_lshl_add_u32 v62, v62, 10, v63
    v_add_u32 v62, s8, v62
    v_subrev_u32 v63, 8192, v62
    s_lshl_b32 s8, s3, 10
    s_mov_b32 s88, 57344
    s_cmp_eq_u32 s3, 0
    s_cselect_b32 s88, s88, 0x7f000000
    s_mov_b32 s86, 24576
    s_mov_b32 s87, 32768
    s_add_u32 m0, s8, 139264
    s_nop 0
    buffer_load_dwordx4 v63, s[48:51], 0 offen nt lds
    s_add_u32 m0, s8, 143360
    s_nop 0
    buffer_load_dwordx4 v62, s[48:51], s86 offen nt lds
    s_add_u32 m0, s8, 147456
    s_nop 0
    buffer_load_dwordx4 v62, s[48:51], s88 offen nt lds
    s_add_u32 m0, s8, 151552
    s_nop 0
    buffer_load_dwordx4 v62, s[52:55], 0 offen nt lds
    s_add_u32 m0, s8, 155648
    s_nop 0
    buffer_load_dwordx4 v62, s[52:55], s87 offen nt lds
    s_waitcnt vmcnt(29)
    s_barrier
    s_mul_i32 s82, s91, 88064
    s_add_u32 s82, s82, s97
    s_add_u32 m0, s100, 0
    s_nop 0
    buffer_load_dwordx4 v12, s[64:67], s82 offen offset:0 lds
    s_add_u32 m0, s100, 1984
    s_nop 0
    buffer_load_dwordx4 v12, s[64:67], s82 offen offset:64 lds
    s_add_u32 m0, s100, 3968
    s_nop 0
    buffer_load_dwordx4 v12, s[64:67], s82 offen offset:128 lds
    s_add_u32 s91, s91, 1
    s_and_b32 s91, s91, 15
    s_add_u32 m0, s99, 34816
    s_add_u32 s83, s98, s85
    buffer_load_dwordx4 v10, s[44:47], s83 offen lds
    s_add_u32 m0, s99, 35840
    s_add_u32 s83, s98, s85
    buffer_load_dwordx4 v11, s[44:47], s83 offen lds
    s_add_u32 s85, s85, 128
    s_and_b32 s85, s85, 1023
    s_waitcnt vmcnt(29)
    s_barrier
    s_mul_i32 s82, s91, 88064
    s_add_u32 s82, s82, s97
    s_add_u32 m0, s100, 12288
    s_nop 0
    buffer_load_dwordx4 v12, s[64:67], s82 offen offset:0 lds
    s_add_u32 m0, s100, 14272
    s_nop 0
    buffer_load_dwordx4 v12, s[64:67], s82 offen offset:64 lds
    s_add_u32 m0, s100, 16256
    s_nop 0
    buffer_load_dwordx4 v12, s[64:67], s82 offen offset:128 lds
    s_add_u32 s91, s91, 1
    s_and_b32 s91, s91, 15
    s_add_u32 m0, s99, 49152
    s_add_u32 s83, s96, s84
    buffer_load_dwordx4 v10, s[44:47], s83 offen lds
    s_add_u32 m0, s99, 50176
    s_add_u32 s83, s96, s84
    buffer_load_dwordx4 v11, s[44:47], s83 offen lds
    s_add_u32 s84, s84, 128
    s_and_b32 s84, s84, 1023
    s_waitcnt vmcnt(29)
    s_barrier
    s_mul_i32 s82, s91, 88064
    s_add_u32 s82, s82, s97
    s_add_u32 m0, s100, 24576
    s_nop 0
    buffer_load_dwordx4 v12, s[64:67], s82 offen offset:0 lds
    s_add_u32 m0, s100, 26560
    s_nop 0
    buffer_load_dwordx4 v12, s[64:67], s82 offen offset:64 lds
    s_add_u32 m0, s100, 28544
    s_nop 0
    buffer_load_dwordx4 v12, s[64:67], s82 offen offset:128 lds
    s_add_u32 s91, s91, 1
    s_and_b32 s91, s91, 15
    s_add_u32 m0, s99, 51200
    s_add_u32 s83, s98, s85
    buffer_load_dwordx4 v10, s[44:47], s83 offen lds
    s_add_u32 m0, s99, 52224
    s_add_u32 s83, s98, s85
    buffer_load_dwordx4 v11, s[44:47], s83 offen lds
    s_add_u32 s85, s85, 128
    s_and_b32 s85, s85, 1023
    s_waitcnt vmcnt(15)
    s_barrier
    s_mul_i32 s82, s91, 88064
    s_add_u32 s82, s82, s97
    s_add_u32 m0, s100, 36864
    s_nop 0
    buffer_load_dwordx4 v12, s[64:67], s82 offen offset:0 lds
    s_add_u32 m0, s100, 38848
    s_nop 0
    buffer_load_dwordx4 v12, s[64:67], s82 offen offset:64 lds
    s_add_u32 m0, s100, 40832
    s_nop 0
    buffer_load_dwordx4 v12, s[64:67], s82 offen offset:128 lds
    s_add_u32 s91, s91, 1
    s_and_b32 s91, s91, 15
    ds_read_b64 v[16:17], v5 offset:640
    ds_read_b64 v[18:19], v5 offset:768
    ds_read_b64 v[20:21], v5 offset:896
    ds_read_b64 v[22:23], v6 offset:1024
    ds_read_b64 v[24:25], v6 offset:1152
    ds_read_b64 v[26:27], v6 offset:1280
    ds_read_b64 v[28:29], v6 offset:1408
    ds_read_b64 v[30:31], v4 offset:12288
    ds_read_b64 v[32:33], v4 offset:12416
    ds_read_b64 v[34:35], v4 offset:12544
    ds_read_b64 v[36:37], v4 offset:12672
    s_barrier
    v_lshlrev_b32 v13, 7, v1
    s_mul_i32 s14, s5, 43
    s_mul_i32 s94, s3, 11
    s_add_u32 s14, s14, s94
    s_lshl_b32 s14, s14, 10
    s_add_u32 s15, s14, 8192
    s_lshl_b32 s94, s4, 18
    s_lshl_b32 s95, s5, 13
    s_add_u32 s94, s94, s95
    s_lshl_b32 s95, s3, 11
    s_add_u32 s94, s94, s95
    s_mov_b32 exec_hi, 0
    s_mov_b32 exec_lo, 0xffff
    buffer_load_dword v204, v13, s[60:63], s94 offen
    s_mov_b32 exec_lo, 0xffffff
    buffer_load_dword v203, v13, s[68:71], s15 offen
    s_mov_b64 exec, -1
    buffer_load_dword v202, v13, s[68:71], s14 offen
    s_getpc_b64 s[20:21]
gmix_phase1_kernel_pc:
    s_add_u32 s20, s20, gmix_phase2_kernel-gmix_phase1_kernel_pc
    s_addc_u32 s21, s21, 0
    s_mov_b32 s22, 9216
    s_mov_b32 s23, 0x00020000
    s_lshl_b32 s94, s3, 12
    s_mov_b32 exec_hi, 0
    buffer_load_dword v205, v13, s[20:23], s94 offen
    s_mov_b32 exec_hi, -1
    s_waitcnt lgkmcnt(0)
    v_lshlrev_b32 v100, 16, v16
    v_and_b32 v101, 0xffff0000, v16
    v_lshlrev_b32 v102, 16, v17
    v_and_b32 v103, 0xffff0000, v17
    v_lshlrev_b32 v104, 16, v18
    v_and_b32 v105, 0xffff0000, v18
    v_lshlrev_b32 v106, 16, v19
    v_and_b32 v107, 0xffff0000, v19
    v_lshlrev_b32 v108, 16, v20
    v_and_b32 v109, 0xffff0000, v20
    v_lshlrev_b32 v110, 16, v21
    v_and_b32 v111, 0xffff0000, v21
    v_lshlrev_b32 v112, 16, v22
    v_and_b32 v113, 0xffff0000, v22
    v_lshlrev_b32 v114, 16, v23
    v_and_b32 v115, 0xffff0000, v23
    v_lshlrev_b32 v116, 16, v24
    v_and_b32 v117, 0xffff0000, v24
    v_lshlrev_b32 v118, 16, v25
    v_and_b32 v119, 0xffff0000, v25
    v_lshlrev_b32 v120, 16, v26
    v_and_b32 v121, 0xffff0000, v26
    s_waitcnt vmcnt(17)
    s_barrier
    v_lshlrev_b32 v122, 16, v27
    v_and_b32 v123, 0xffff0000, v27
    v_lshlrev_b32 v124, 16, v28
    v_and_b32 v125, 0xffff0000, v28
    v_lshlrev_b32 v126, 16, v29
    v_and_b32 v127, 0xffff0000, v29
    v_lshlrev_b32 v128, 16, v30
    v_and_b32 v129, 0xffff0000, v30
    v_lshlrev_b32 v130, 16, v31
    v_and_b32 v131, 0xffff0000, v31
    v_lshlrev_b32 v132, 16, v32
    v_and_b32 v133, 0xffff0000, v32
    v_lshlrev_b32 v134, 16, v33
    v_and_b32 v135, 0xffff0000, v33
    v_lshlrev_b32 v136, 16, v34
    v_and_b32 v137, 0xffff0000, v34
    v_lshlrev_b32 v138, 16, v35
    v_and_b32 v139, 0xffff0000, v35
    v_lshlrev_b32 v140, 16, v36
    v_and_b32 v141, 0xffff0000, v36
    v_lshlrev_b32 v142, 16, v37
    v_and_b32 v143, 0xffff0000, v37
    s_waitcnt vmcnt(14)
    s_barrier
    v_lshlrev_b32 v144, 16, v38
    v_and_b32 v148, 0xffff0000, v38
    v_lshlrev_b32 v152, 16, v39
    v_and_b32 v156, 0xffff0000, v39
    v_lshlrev_b32 v145, 16, v40
    v_and_b32 v149, 0xffff0000, v40
    v_lshlrev_b32 v153, 16, v41
    v_and_b32 v157, 0xffff0000, v41
    v_lshlrev_b32 v146, 16, v42
    v_and_b32 v150, 0xffff0000, v42
    v_lshlrev_b32 v154, 16, v43
    v_and_b32 v158, 0xffff0000, v43
    v_lshlrev_b32 v147, 16, v44
    v_and_b32 v151, 0xffff0000, v44
    v_lshlrev_b32 v155, 16, v45
    v_and_b32 v159, 0xffff0000, v45
    v_pk_mul_f32 v[160:161], v[100:101], v[156:157]
    v_pk_fma_f32 v[160:161], v[104:105], v[152:153], v[160:161]
    v_pk_fma_f32 v[160:161], v[108:109], v[148:149], v[160:161]
    v_pk_fma_f32 v[160:161], v[112:113], v[144:145], v[160:161]
    v_pk_mul_f32 v[160:161], v[160:161], v[128:129]
    v_pk_mul_f32 v[162:163], v[102:103], v[158:159]
    s_waitcnt vmcnt(7)
    s_barrier
    v_pk_fma_f32 v[162:163], v[106:107], v[154:155], v[162:163]
    v_pk_fma_f32 v[162:163], v[110:111], v[150:151], v[162:163]
    v_pk_fma_f32 v[162:163], v[114:115], v[146:147], v[162:163]
    v_pk_mul_f32 v[162:163], v[162:163], v[130:131]
    v_pk_mul_f32 v[164:165], v[104:105], v[156:157]
    v_pk_fma_f32 v[164:165], v[108:109], v[152:153], v[164:165]
    v_pk_fma_f32 v[164:165], v[112:113], v[148:149], v[164:165]
    v_pk_fma_f32 v[164:165], v[116:117], v[144:145], v[164:165]
    v_pk_mul_f32 v[164:165], v[164:165], v[132:133]
    v_pk_mul_f32 v[166:167], v[106:107], v[158:159]
    v_pk_fma_f32 v[166:167], v[110:111], v[154:155], v[166:167]
    v_pk_fma_f32 v[166:167], v[114:115], v[150:151], v[166:167]
    v_pk_fma_f32 v[166:167], v[118:119], v[146:147], v[166:167]
    v_pk_mul_f32 v[166:167], v[166:167], v[134:135]
    v_pk_mul_f32 v[168:169], v[108:109], v[156:157]
    v_pk_fma_f32 v[168:169], v[112:113], v[152:153], v[168:169]
    v_pk_fma_f32 v[168:169], v[116:117], v[148:149], v[168:169]
    v_pk_fma_f32 v[168:169], v[120:121], v[144:145], v[168:169]
    v_pk_mul_f32 v[168:169], v[168:169], v[136:137]
    v_pk_mul_f32 v[170:171], v[110:111], v[158:159]
    v_pk_fma_f32 v[170:171], v[114:115], v[154:155], v[170:171]
    v_pk_fma_f32 v[170:171], v[118:119], v[150:151], v[170:171]
    s_waitcnt vmcnt(4)
    s_barrier
    v_pk_fma_f32 v[170:171], v[122:123], v[146:147], v[170:171]
    v_pk_mul_f32 v[170:171], v[170:171], v[138:139]
    v_pk_mul_f32 v[172:173], v[112:113], v[156:157]
    v_pk_fma_f32 v[172:173], v[116:117], v[152:153], v[172:173]
    v_pk_fma_f32 v[172:173], v[120:121], v[148:149], v[172:173]
    v_pk_fma_f32 v[172:173], v[124:125], v[144:145], v[172:173]
    v_pk_mul_f32 v[172:173], v[172:173], v[140:141]
    v_pk_mul_f32 v[174:175], v[114:115], v[158:159]
    v_pk_fma_f32 v[174:175], v[118:119], v[154:155], v[174:175]
    v_pk_fma_f32 v[174:175], v[122:123], v[150:151], v[174:175]
    v_pk_fma_f32 v[174:175], v[126:127], v[146:147], v[174:175]
    v_pk_mul_f32 v[174:175], v[174:175], v[142:143]
    v_cvt_pk_bf16_f32 v60, v172, v168
    v_cvt_pk_bf16_f32 v61, v164, v160
    v_cvt_pk_bf16_f32 v62, v173, v169
    v_cvt_pk_bf16_f32 v63, v165, v161
    v_cvt_pk_bf16_f32 v64, v174, v170
    v_cvt_pk_bf16_f32 v65, v166, v162
    v_cvt_pk_bf16_f32 v66, v175, v171
    v_cvt_pk_bf16_f32 v67, v167, v163
    v_xor_b32 v8, 1, v2
    v_lshlrev_b32 v8, 3, v8
    v_lshl_add_u32 v8, v3, 9, v8
    s_lshl_b32 s94, s3, 11
    s_add_u32 s94, s94, 0
    v_add_u32 v8, s94, v8
    v_add_u32 v9, s94, v7
    ds_write_b64 v8, v[60:61] offset:0
    ds_write_b64 v8, v[62:63] offset:128
    ds_write_b64 v8, v[64:65] offset:256
    ds_write_b64 v8, v[66:67] offset:384
    s_waitcnt lgkmcnt(0)
    ds_read_b128 v[16:19], v9
    ds_read_b128 v[20:23], v9 offset:1024
    v_lshrrev_b32 v8, 3, v1
    v_and_b32 v9, 7, v1
    v_lshlrev_b32 v9, 4, v9
    v_lshl_add_u32 v8, v8, 12, v9
    s_lshl_b32 s94, s13, 11
    s_lshl_b32 s95, s12, 7
    s_add_u32 s94, s94, s95
    s_add_u32 s95, s94, 32768
    s_waitcnt lgkmcnt(1)
    buffer_store_dwordx4 v[16:19], v8, s[76:79], s94 offen sc1
    s_waitcnt lgkmcnt(0)
    buffer_store_dwordx4 v[20:23], v8, s[76:79], s95 offen sc1
gmix_phase1_kernel_end:
    s_endpgm
    .globl gmix_phase2_kernel
    .p2align 8
    .type gmix_phase2_kernel,@function
gmix_phase2_kernel:
    s_cmp_ge_u32 s2, 256
    s_cbranch_scc1 gmix_phase2_kernel_end
    s_load_dwordx2 s[4:5], s[0:1], 0
    s_load_dwordx4 s[8:11], s[0:1], 32
    s_load_dwordx2 s[6:7], s[0:1], 72
    s_load_dwordx4 s[12:15], s[0:1], 88
    s_load_dwordx2 s[16:17], s[0:1], 104
    v_and_b32 v1, 63, v0
    v_lshrrev_b32 v2, 6, v0
    v_lshlrev_b32 v3, 4, v1
    v_readfirstlane_b32 s69, v2
    s_and_b32 s25, s2, 1
    s_lshl_b32 s25, s25, 2
    s_bfe_u32 s27, s2, 0x20001
    s_add_u32 s25, s25, s27
    s_lshl_b32 s25, s25, 2
    s_lshr_b32 s27, s2, 6
    s_add_u32 s25, s25, s27
    s_bfe_u32 s26, s2, 0x30003
    s_lshl_b32 s34, s26, 7
    v_and_b32 v8, 7, v1
    v_lshrrev_b32 v9, 3, v1
    s_and_b32 s24, s69, 3
    s_cmp_ge_u32 s69, 4
    s_cbranch_scc1 gmix_phase2_kernel_conv
    s_mul_i32 s27, s25, 176128
    s_add_u32 s27, s27, 8388608
    v_add_u32 v4, s27, v3
    v_add_u32 v5, 88064, v4
    v_bfe_u32 v6, v1, 4, 1
    v_lshlrev_b32 v6, 2, v6
    v_xor_b32 v6, v6, v8
    v_lshlrev_b32 v6, 4, v6
    v_lshl_add_u32 v6, v9, 10, v6
    v_add_u32 v6, s34, v6
    v_add_u32 v7, 8192, v6
    s_lshl_b32 s30, s24, 10
    s_lshl_b32 s29, s24, 14
    s_mul_i32 s28, s24, 28672
    s_waitcnt lgkmcnt(0)
    s_mov_b32 s48, s16
    s_mov_b32 s49, s17
    s_mov_b32 s50, 16777216
    s_mov_b32 s51, 0x00020000
    s_mov_b32 s52, s6
    s_mov_b32 s53, s7
    s_mov_b32 s54, 1409024
    s_mov_b32 s55, 0x00020000
    s_barrier
    s_add_u32 m0, s28, 0
    s_nop 0
    buffer_load_dwordx4 v6, s[52:55], s29 offen lds
    s_add_u32 m0, s28, 1024
    s_nop 0
    buffer_load_dwordx4 v7, s[52:55], s29 offen lds
    s_add_u32 s29, s29, 65536
    s_mov_b32 s40, s4
    buffer_load_dwordx4 v[80:83], v4, s[48:51], s30 offen
    s_mov_b32 s41, s5
    buffer_load_dwordx4 v[84:87], v5, s[48:51], s30 offen
    s_add_u32 s30, s30, 4096
    s_mov_b32 s42, 2097152
    s_add_u32 m0, s28, 2048
    s_nop 0
    buffer_load_dwordx4 v6, s[52:55], s29 offen lds
    s_add_u32 m0, s28, 3072
    s_nop 0
    buffer_load_dwordx4 v7, s[52:55], s29 offen lds
    s_add_u32 s29, s29, 65536
    s_mov_b32 s43, 0x00020000
    buffer_load_dwordx4 v[88:91], v4, s[48:51], s30 offen
    s_mov_b32 s44, s12
    buffer_load_dwordx4 v[92:95], v5, s[48:51], s30 offen
    s_add_u32 s30, s30, 4096
    s_mov_b32 s45, s13
    s_add_u32 m0, s28, 4096
    s_nop 0
    buffer_load_dwordx4 v6, s[52:55], s29 offen lds
    s_add_u32 m0, s28, 5120
    s_nop 0
    buffer_load_dwordx4 v7, s[52:55], s29 offen lds
    s_add_u32 s29, s29, 65536
    s_mov_b32 s46, 2097152
    buffer_load_dwordx4 v[96:99], v4, s[48:51], s30 offen
    s_mov_b32 s47, 0x00020000
    buffer_load_dwordx4 v[100:103], v5, s[48:51], s30 offen
    s_add_u32 s30, s30, 4096
    v_lshrrev_b32 v42, 5, v1
    s_add_u32 m0, s28, 6144
    s_nop 0
    buffer_load_dwordx4 v6, s[52:55], s29 offen lds
    s_add_u32 m0, s28, 7168
    s_nop 0
    buffer_load_dwordx4 v7, s[52:55], s29 offen lds
    s_add_u32 s29, s29, 65536
    v_bfe_u32 v43, v1, 2, 2
    buffer_load_dwordx4 v[104:107], v4, s[48:51], s30 offen
    v_lshl_add_u32 v42, v42, 2, v43
    buffer_load_dwordx4 v[108:111], v5, s[48:51], s30 offen
    s_add_u32 s30, s30, 4096
    v_lshlrev_b32 v42, 7, v42
    s_add_u32 m0, s28, 8192
    s_nop 0
    buffer_load_dwordx4 v6, s[52:55], s29 offen lds
    s_add_u32 m0, s28, 9216
    s_nop 0
    buffer_load_dwordx4 v7, s[52:55], s29 offen lds
    s_add_u32 s29, s29, 65536
    v_bfe_u32 v43, v1, 3, 1
    buffer_load_dwordx4 v[112:115], v4, s[48:51], s30 offen
    v_lshl_add_u32 v42, v43, 6, v42
    buffer_load_dwordx4 v[116:119], v5, s[48:51], s30 offen
    s_add_u32 s30, s30, 4096
    v_bfe_u32 v43, v1, 4, 1
    s_add_u32 m0, s28, 10240
    s_nop 0
    buffer_load_dwordx4 v6, s[52:55], s29 offen lds
    s_add_u32 m0, s28, 11264
    s_nop 0
    buffer_load_dwordx4 v7, s[52:55], s29 offen lds
    s_add_u32 s29, s29, 65536
    v_lshl_add_u32 v42, v43, 5, v42
    buffer_load_dwordx4 v[120:123], v4, s[48:51], s30 offen
    v_and_b32 v43, 3, v1
    buffer_load_dwordx4 v[124:127], v5, s[48:51], s30 offen
    s_add_u32 s30, s30, 4096
    v_lshl_add_u32 v42, v43, 3, v42
    s_add_u32 m0, s28, 12288
    s_nop 0
    buffer_load_dwordx4 v6, s[52:55], s29 offen lds
    s_add_u32 m0, s28, 13312
    s_nop 0
    buffer_load_dwordx4 v7, s[52:55], s29 offen lds
    s_add_u32 s29, s29, 65536
    v_add_u32 v14, s28, v42
    buffer_load_dwordx4 v[128:131], v4, s[48:51], s30 offen
    v_xor_b32 v15, 64, v14
    buffer_load_dwordx4 v[132:135], v5, s[48:51], s30 offen
    s_add_u32 s30, s30, 4096
    v_and_b32 v42, 31, v1
    s_add_u32 m0, s28, 14336
    s_nop 0
    buffer_load_dwordx4 v6, s[52:55], s29 offen lds
    s_add_u32 m0, s28, 15360
    s_nop 0
    buffer_load_dwordx4 v7, s[52:55], s29 offen lds
    s_add_u32 s29, s29, 65536
    v_lshrrev_b32 v43, 5, v1
    buffer_load_dwordx4 v[136:139], v4, s[48:51], s30 offen
    v_and_b32 v44, 7, v42
    buffer_load_dwordx4 v[140:143], v5, s[48:51], s30 offen
    s_add_u32 s30, s30, 4096
    v_xor_b32 v43, v43, v44
    s_add_u32 m0, s28, 16384
    s_nop 0
    buffer_load_dwordx4 v6, s[52:55], s29 offen lds
    s_add_u32 m0, s28, 17408
    s_nop 0
    buffer_load_dwordx4 v7, s[52:55], s29 offen lds
    s_add_u32 s29, s29, 65536
    v_lshlrev_b32 v43, 4, v43
    buffer_load_dwordx4 v[144:147], v4, s[48:51], s30 offen
    v_lshl_add_u32 v43, v42, 8, v43
    buffer_load_dwordx4 v[148:151], v5, s[48:51], s30 offen
    s_add_u32 s30, s30, 4096
    v_add_u32 v44, s28, v43
    s_add_u32 m0, s28, 18432
    s_nop 0
    buffer_load_dwordx4 v6, s[52:55], s29 offen lds
    s_add_u32 m0, s28, 19456
    s_nop 0
    buffer_load_dwordx4 v7, s[52:55], s29 offen lds
    s_add_u32 s29, s29, 65536
    v_xor_b32 v45, 32, v44
    buffer_load_dwordx4 v[152:155], v4, s[48:51], s30 offen
    v_xor_b32 v46, 64, v44
    buffer_load_dwordx4 v[156:159], v5, s[48:51], s30 offen
    s_add_u32 s30, s30, 4096
    v_xor_b32 v47, 96, v44
    s_waitcnt vmcnt(38)
    ds_read_b64_tr_b16 v[60:61], v14 offset:0
    ds_read_b64_tr_b16 v[62:63], v14 offset:1024
    ds_read_b64_tr_b16 v[64:65], v15 offset:0
    ds_read_b64_tr_b16 v[66:67], v15 offset:1024
    s_waitcnt vmcnt(36) lgkmcnt(2)
    v_mfma_f32_32x32x16_bf16 v[192:207], v[60:63], v[80:83], 0
    s_waitcnt vmcnt(34)
    ds_read_b64_tr_b16 v[68:69], v14 offset:2048
    ds_read_b64_tr_b16 v[70:71], v14 offset:3072
    v_mfma_f32_32x32x16_bf16 v[224:239], v[60:63], v[84:87], 0
    ds_read_b64_tr_b16 v[72:73], v15 offset:2048
    ds_read_b64_tr_b16 v[74:75], v15 offset:3072
    s_waitcnt lgkmcnt(4)
    v_mfma_f32_32x32x16_bf16 v[208:223], v[64:67], v[80:83], 0
    s_add_u32 m0, s28, 20480
    s_nop 0
    buffer_load_dwordx4 v6, s[52:55], s29 offen lds
    s_add_u32 m0, s28, 21504
    s_nop 0
    buffer_load_dwordx4 v7, s[52:55], s29 offen lds
    s_add_u32 s29, s29, 65536
    v_mfma_f32_32x32x16_bf16 v[240:255], v[64:67], v[84:87], 0
    buffer_load_dwordx4 v[160:163], v4, s[48:51], s30 offen
    buffer_load_dwordx4 v[164:167], v5, s[48:51], s30 offen
    s_add_u32 s30, s30, 4096
    s_waitcnt vmcnt(36) lgkmcnt(2)
    v_mfma_f32_32x32x16_bf16 v[192:207], v[68:71], v[88:91], v[192:207]
    s_waitcnt vmcnt(34)
    ds_read_b64_tr_b16 v[60:61], v14 offset:4096
    ds_read_b64_tr_b16 v[62:63], v14 offset:5120
    v_mfma_f32_32x32x16_bf16 v[224:239], v[68:71], v[92:95], v[224:239]
    ds_read_b64_tr_b16 v[64:65], v15 offset:4096
    ds_read_b64_tr_b16 v[66:67], v15 offset:5120
    s_waitcnt lgkmcnt(4)
    v_mfma_f32_32x32x16_bf16 v[208:223], v[72:75], v[88:91], v[208:223]
    s_add_u32 m0, s28, 22528
    s_nop 0
    buffer_load_dwordx4 v6, s[52:55], s29 offen lds
    s_add_u32 m0, s28, 23552
    s_nop 0
    buffer_load_dwordx4 v7, s[52:55], s29 offen lds
    s_add_u32 s29, s29, 65536
    v_mfma_f32_32x32x16_bf16 v[240:255], v[72:75], v[92:95], v[240:255]
    buffer_load_dwordx4 v[168:171], v4, s[48:51], s30 offen
    buffer_load_dwordx4 v[172:175], v5, s[48:51], s30 offen
    s_add_u32 s30, s30, 4096
    s_waitcnt vmcnt(36) lgkmcnt(2)
    v_mfma_f32_32x32x16_bf16 v[192:207], v[60:63], v[96:99], v[192:207]
    s_waitcnt vmcnt(34)
    ds_read_b64_tr_b16 v[68:69], v14 offset:6144
    ds_read_b64_tr_b16 v[70:71], v14 offset:7168
    v_mfma_f32_32x32x16_bf16 v[224:239], v[60:63], v[100:103], v[224:239]
    ds_read_b64_tr_b16 v[72:73], v15 offset:6144
    ds_read_b64_tr_b16 v[74:75], v15 offset:7168
    s_waitcnt lgkmcnt(4)
    v_mfma_f32_32x32x16_bf16 v[208:223], v[64:67], v[96:99], v[208:223]
    s_add_u32 m0, s28, 24576
    s_nop 0
    buffer_load_dwordx4 v6, s[52:55], s29 offen lds
    s_add_u32 m0, s28, 25600
    s_nop 0
    buffer_load_dwordx4 v7, s[52:55], s29 offen lds
    s_add_u32 s29, s29, 65536
    v_mfma_f32_32x32x16_bf16 v[240:255], v[64:67], v[100:103], v[240:255]
    buffer_load_dwordx4 v[176:179], v4, s[48:51], s30 offen
    buffer_load_dwordx4 v[180:183], v5, s[48:51], s30 offen
    s_add_u32 s30, s30, 4096
    s_waitcnt vmcnt(36) lgkmcnt(2)
    v_mfma_f32_32x32x16_bf16 v[192:207], v[68:71], v[104:107], v[192:207]
    s_waitcnt vmcnt(34)
    ds_read_b64_tr_b16 v[60:61], v14 offset:8192
    ds_read_b64_tr_b16 v[62:63], v14 offset:9216
    v_mfma_f32_32x32x16_bf16 v[224:239], v[68:71], v[108:111], v[224:239]
    ds_read_b64_tr_b16 v[64:65], v15 offset:8192
    ds_read_b64_tr_b16 v[66:67], v15 offset:9216
    s_waitcnt lgkmcnt(4)
    v_mfma_f32_32x32x16_bf16 v[208:223], v[72:75], v[104:107], v[208:223]
    s_add_u32 m0, s28, 26624
    s_nop 0
    buffer_load_dwordx4 v6, s[52:55], s29 offen lds
    s_add_u32 m0, s28, 27648
    s_nop 0
    buffer_load_dwordx4 v7, s[52:55], s29 offen lds
    s_add_u32 s29, s29, 65536
    v_mfma_f32_32x32x16_bf16 v[240:255], v[72:75], v[108:111], v[240:255]
    buffer_load_dwordx4 v[184:187], v4, s[48:51], s30 offen
    buffer_load_dwordx4 v[188:191], v5, s[48:51], s30 offen
    s_add_u32 s30, s30, 4096
    s_waitcnt vmcnt(36) lgkmcnt(2)
    v_mfma_f32_32x32x16_bf16 v[192:207], v[60:63], v[112:115], v[192:207]
    s_waitcnt vmcnt(34)
    ds_read_b64_tr_b16 v[68:69], v14 offset:10240
    ds_read_b64_tr_b16 v[70:71], v14 offset:11264
    v_mfma_f32_32x32x16_bf16 v[224:239], v[60:63], v[116:119], v[224:239]
    ds_read_b64_tr_b16 v[72:73], v15 offset:10240
    ds_read_b64_tr_b16 v[74:75], v15 offset:11264
    s_waitcnt lgkmcnt(4)
    v_mfma_f32_32x32x16_bf16 v[208:223], v[64:67], v[112:115], v[208:223]
    s_add_u32 m0, s28, 0
    s_nop 0
    buffer_load_dwordx4 v6, s[52:55], s29 offen lds
    s_add_u32 m0, s28, 1024
    s_nop 0
    buffer_load_dwordx4 v7, s[52:55], s29 offen lds
    s_add_u32 s29, s29, 65536
    v_mfma_f32_32x32x16_bf16 v[240:255], v[64:67], v[116:119], v[240:255]
    buffer_load_dwordx4 v[80:83], v4, s[48:51], s30 offen
    buffer_load_dwordx4 v[84:87], v5, s[48:51], s30 offen
    s_add_u32 s30, s30, 4096
    s_waitcnt vmcnt(36) lgkmcnt(2)
    v_mfma_f32_32x32x16_bf16 v[192:207], v[68:71], v[120:123], v[192:207]
    s_waitcnt vmcnt(34)
    ds_read_b64_tr_b16 v[60:61], v14 offset:12288
    ds_read_b64_tr_b16 v[62:63], v14 offset:13312
    v_mfma_f32_32x32x16_bf16 v[224:239], v[68:71], v[124:127], v[224:239]
    ds_read_b64_tr_b16 v[64:65], v15 offset:12288
    ds_read_b64_tr_b16 v[66:67], v15 offset:13312
    s_waitcnt lgkmcnt(4)
    v_mfma_f32_32x32x16_bf16 v[208:223], v[72:75], v[120:123], v[208:223]
    s_add_u32 m0, s28, 2048
    s_nop 0
    buffer_load_dwordx4 v6, s[52:55], s29 offen lds
    s_add_u32 m0, s28, 3072
    s_nop 0
    buffer_load_dwordx4 v7, s[52:55], s29 offen lds
    s_add_u32 s29, s29, 65536
    v_mfma_f32_32x32x16_bf16 v[240:255], v[72:75], v[124:127], v[240:255]
    buffer_load_dwordx4 v[88:91], v4, s[48:51], s30 offen
    buffer_load_dwordx4 v[92:95], v5, s[48:51], s30 offen
    s_add_u32 s30, s30, 4096
    s_waitcnt vmcnt(36) lgkmcnt(2)
    v_mfma_f32_32x32x16_bf16 v[192:207], v[60:63], v[128:131], v[192:207]
    s_waitcnt vmcnt(34)
    ds_read_b64_tr_b16 v[68:69], v14 offset:14336
    ds_read_b64_tr_b16 v[70:71], v14 offset:15360
    ds_read_b64_tr_b16 v[72:73], v15 offset:14336
    v_mfma_f32_32x32x16_bf16 v[224:239], v[60:63], v[132:135], v[224:239]
    ds_read_b64_tr_b16 v[74:75], v15 offset:15360
    s_add_u32 m0, s28, 4096
    s_nop 0
    buffer_load_dwordx4 v6, s[52:55], s29 offen lds
    s_add_u32 m0, s28, 5120
    s_nop 0
    buffer_load_dwordx4 v7, s[52:55], s29 offen lds
    s_add_u32 s29, s29, 65536
    buffer_load_dwordx4 v[96:99], v4, s[48:51], s30 offen
    s_waitcnt lgkmcnt(4)
    v_mfma_f32_32x32x16_bf16 v[208:223], v[64:67], v[128:131], v[208:223]
    buffer_load_dwordx4 v[100:103], v5, s[48:51], s30 offen
    s_add_u32 s30, s30, 4096
    s_lshl_b32 s33, s25, 6
    s_lshl_b32 s35, s69, 3
    s_add_u32 s33, s33, s35
    v_add_u32 v12, s33, v9
    v_lshlrev_b32 v13, 2, v12
    v_add_u32 v13, 4194304, v13
    v_lshlrev_b32 v12, 10, v12
    v_mfma_f32_32x32x16_bf16 v[240:255], v[64:67], v[132:135], v[240:255]
    v_lshl_add_u32 v12, v8, 4, v12
    v_add_u32 v12, s34, v12
    buffer_load_dwordx4 v[24:27], v12, s[40:43], 0 offen
    buffer_load_dword v28, v13, s[48:51], 0 offen
    s_waitcnt vmcnt(38) lgkmcnt(2)
    v_mfma_f32_32x32x16_bf16 v[192:207], v[68:71], v[136:139], v[192:207]
    s_waitcnt vmcnt(36)
    ds_read_b64_tr_b16 v[60:61], v14 offset:16384
    ds_read_b64_tr_b16 v[62:63], v14 offset:17408
    v_mfma_f32_32x32x16_bf16 v[224:239], v[68:71], v[140:143], v[224:239]
    ds_read_b64_tr_b16 v[64:65], v15 offset:16384
    ds_read_b64_tr_b16 v[66:67], v15 offset:17408
    s_waitcnt lgkmcnt(4)
    v_mfma_f32_32x32x16_bf16 v[208:223], v[72:75], v[136:139], v[208:223]
    s_add_u32 m0, s28, 6144
    s_nop 0
    buffer_load_dwordx4 v6, s[52:55], s29 offen lds
    s_add_u32 m0, s28, 7168
    s_nop 0
    buffer_load_dwordx4 v7, s[52:55], s29 offen lds
    s_add_u32 s29, s29, 65536
    v_mfma_f32_32x32x16_bf16 v[240:255], v[72:75], v[140:143], v[240:255]
    buffer_load_dwordx4 v[104:107], v4, s[48:51], s30 offen
    buffer_load_dwordx4 v[108:111], v5, s[48:51], s30 offen
    s_add_u32 s30, s30, 4096
    s_waitcnt vmcnt(38) lgkmcnt(2)
    v_mfma_f32_32x32x16_bf16 v[192:207], v[60:63], v[144:147], v[192:207]
    s_waitcnt vmcnt(36)
    ds_read_b64_tr_b16 v[68:69], v14 offset:18432
    ds_read_b64_tr_b16 v[70:71], v14 offset:19456
    v_mfma_f32_32x32x16_bf16 v[224:239], v[60:63], v[148:151], v[224:239]
    ds_read_b64_tr_b16 v[72:73], v15 offset:18432
    ds_read_b64_tr_b16 v[74:75], v15 offset:19456
    s_waitcnt lgkmcnt(4)
    v_mfma_f32_32x32x16_bf16 v[208:223], v[64:67], v[144:147], v[208:223]
    s_add_u32 m0, s28, 8192
    s_nop 0
    buffer_load_dwordx4 v6, s[52:55], s29 offen lds
    s_add_u32 m0, s28, 9216
    s_nop 0
    buffer_load_dwordx4 v7, s[52:55], s29 offen lds
    s_add_u32 s29, s29, 65536
    v_mfma_f32_32x32x16_bf16 v[240:255], v[64:67], v[148:151], v[240:255]
    buffer_load_dwordx4 v[112:115], v4, s[48:51], s30 offen
    buffer_load_dwordx4 v[116:119], v5, s[48:51], s30 offen
    s_add_u32 s30, s30, 4096
    s_waitcnt vmcnt(38) lgkmcnt(2)
    v_mfma_f32_32x32x16_bf16 v[192:207], v[68:71], v[152:155], v[192:207]
    s_waitcnt vmcnt(36)
    ds_read_b64_tr_b16 v[60:61], v14 offset:20480
    ds_read_b64_tr_b16 v[62:63], v14 offset:21504
    v_mfma_f32_32x32x16_bf16 v[224:239], v[68:71], v[156:159], v[224:239]
    ds_read_b64_tr_b16 v[64:65], v15 offset:20480
    ds_read_b64_tr_b16 v[66:67], v15 offset:21504
    s_waitcnt lgkmcnt(4)
    v_mfma_f32_32x32x16_bf16 v[208:223], v[72:75], v[152:155], v[208:223]
    s_add_u32 m0, s28, 10240
    s_nop 0
    buffer_load_dwordx4 v6, s[52:55], s29 offen lds
    s_add_u32 m0, s28, 11264
    s_nop 0
    buffer_load_dwordx4 v7, s[52:55], s29 offen lds
    s_add_u32 s29, s29, 65536
    v_mfma_f32_32x32x16_bf16 v[240:255], v[72:75], v[156:159], v[240:255]
    buffer_load_dwordx4 v[120:123], v4, s[48:51], s30 offen
    buffer_load_dwordx4 v[124:127], v5, s[48:51], s30 offen
    s_add_u32 s30, s30, 4096
    s_waitcnt vmcnt(38) lgkmcnt(2)
    v_mfma_f32_32x32x16_bf16 v[192:207], v[60:63], v[160:163], v[192:207]
    s_waitcnt vmcnt(36)
    ds_read_b64_tr_b16 v[68:69], v14 offset:22528
    ds_read_b64_tr_b16 v[70:71], v14 offset:23552
    v_mfma_f32_32x32x16_bf16 v[224:239], v[60:63], v[164:167], v[224:239]
    ds_read_b64_tr_b16 v[72:73], v15 offset:22528
    ds_read_b64_tr_b16 v[74:75], v15 offset:23552
    s_waitcnt lgkmcnt(4)
    v_mfma_f32_32x32x16_bf16 v[208:223], v[64:67], v[160:163], v[208:223]
    s_add_u32 m0, s28, 12288
    s_nop 0
    buffer_load_dwordx4 v6, s[52:55], s29 offen lds
    s_add_u32 m0, s28, 13312
    s_nop 0
    buffer_load_dwordx4 v7, s[52:55], s29 offen lds
    s_add_u32 s29, s29, 65536
    v_mfma_f32_32x32x16_bf16 v[240:255], v[64:67], v[164:167], v[240:255]
    buffer_load_dwordx4 v[128:131], v4, s[48:51], s30 offen
    buffer_load_dwordx4 v[132:135], v5, s[48:51], s30 offen
    s_add_u32 s30, s30, 4096
    s_waitcnt vmcnt(38) lgkmcnt(2)
    v_mfma_f32_32x32x16_bf16 v[192:207], v[68:71], v[168:171], v[192:207]
    s_waitcnt vmcnt(36)
    ds_read_b64_tr_b16 v[60:61], v14 offset:24576
    ds_read_b64_tr_b16 v[62:63], v14 offset:25600
    v_mfma_f32_32x32x16_bf16 v[224:239], v[68:71], v[172:175], v[224:239]
    ds_read_b64_tr_b16 v[64:65], v15 offset:24576
    ds_read_b64_tr_b16 v[66:67], v15 offset:25600
    s_waitcnt lgkmcnt(4)
    v_mfma_f32_32x32x16_bf16 v[208:223], v[72:75], v[168:171], v[208:223]
    s_add_u32 m0, s28, 14336
    s_nop 0
    buffer_load_dwordx4 v6, s[52:55], s29 offen lds
    s_add_u32 m0, s28, 15360
    s_nop 0
    buffer_load_dwordx4 v7, s[52:55], s29 offen lds
    s_add_u32 s29, s29, 65536
    v_mfma_f32_32x32x16_bf16 v[240:255], v[72:75], v[172:175], v[240:255]
    s_cmp_ge_u32 s24, 2
    s_cselect_b32 s30, 0x10000000, s30
    buffer_load_dwordx4 v[136:139], v4, s[48:51], s30 offen
    buffer_load_dwordx4 v[140:143], v5, s[48:51], s30 offen
    s_add_u32 s30, s30, 4096
    s_waitcnt vmcnt(38) lgkmcnt(2)
    v_mfma_f32_32x32x16_bf16 v[192:207], v[60:63], v[176:179], v[192:207]
    s_waitcnt vmcnt(36)
    ds_read_b64_tr_b16 v[68:69], v14 offset:26624
    v_mfma_f32_32x32x16_bf16 v[224:239], v[60:63], v[180:183], v[224:239]
    ds_read_b64_tr_b16 v[70:71], v14 offset:27648
    s_waitcnt lgkmcnt(2)
    v_mfma_f32_32x32x16_bf16 v[208:223], v[64:67], v[176:179], v[208:223]
    ds_read_b64_tr_b16 v[72:73], v15 offset:26624
    v_mfma_f32_32x32x16_bf16 v[240:255], v[64:67], v[180:183], v[240:255]
    ds_read_b64_tr_b16 v[74:75], v15 offset:27648
    s_waitcnt vmcnt(34) lgkmcnt(2)
    v_mfma_f32_32x32x16_bf16 v[192:207], v[68:71], v[184:187], v[192:207]
    s_waitcnt vmcnt(32)
    ds_read_b64_tr_b16 v[60:61], v14 offset:0
    v_mfma_f32_32x32x16_bf16 v[224:239], v[68:71], v[188:191], v[224:239]
    ds_read_b64_tr_b16 v[62:63], v14 offset:1024
    s_waitcnt lgkmcnt(2)
    v_mfma_f32_32x32x16_bf16 v[208:223], v[72:75], v[184:187], v[208:223]
    ds_read_b64_tr_b16 v[64:65], v15 offset:0
    v_mfma_f32_32x32x16_bf16 v[240:255], v[72:75], v[188:191], v[240:255]
    ds_read_b64_tr_b16 v[66:67], v15 offset:1024
    s_waitcnt vmcnt(30) lgkmcnt(2)
    v_mfma_f32_32x32x16_bf16 v[192:207], v[60:63], v[80:83], v[192:207]
    s_waitcnt vmcnt(28)
    ds_read_b64_tr_b16 v[68:69], v14 offset:2048
    ds_read_b64_tr_b16 v[70:71], v14 offset:3072
    ds_read_b64_tr_b16 v[72:73], v15 offset:2048
    v_mfma_f32_32x32x16_bf16 v[224:239], v[60:63], v[84:87], v[224:239]
    ds_read_b64_tr_b16 v[74:75], v15 offset:3072
    s_waitcnt vmcnt(20)
    v_sub_f32 v2, 1.0, v28
    v_cvt_pk_bf16_f32 v2, v2, v2
    s_waitcnt lgkmcnt(4)
    v_mfma_f32_32x32x16_bf16 v[208:223], v[64:67], v[80:83], v[208:223]
    v_lshlrev_b32 v2, 16, v2
    v_lshlrev_b32 v16, 16, v24
    v_and_b32 v17, 0xffff0000, v24
    v_mfma_f32_32x32x16_bf16 v[240:255], v[64:67], v[84:87], v[240:255]
    v_mul_f32 v16, v28, v16
    v_mul_f32 v17, v28, v17
    v_lshlrev_b32 v18, 16, v25
    v_and_b32 v19, 0xffff0000, v25
    s_waitcnt lgkmcnt(2)
    v_mfma_f32_32x32x16_bf16 v[192:207], v[68:71], v[88:91], v[192:207]
    ds_read_b64_tr_b16 v[60:61], v14 offset:4096
    ds_read_b64_tr_b16 v[62:63], v14 offset:5120
    ds_read_b64_tr_b16 v[64:65], v15 offset:4096
    v_mfma_f32_32x32x16_bf16 v[224:239], v[68:71], v[92:95], v[224:239]
    ds_read_b64_tr_b16 v[66:67], v15 offset:5120
    v_mul_f32 v18, v28, v18
    v_mul_f32 v19, v28, v19
    s_waitcnt lgkmcnt(4)
    v_mfma_f32_32x32x16_bf16 v[208:223], v[72:75], v[88:91], v[208:223]
    v_lshlrev_b32 v20, 16, v26
    v_and_b32 v21, 0xffff0000, v26
    v_mul_f32 v20, v28, v20
    v_mfma_f32_32x32x16_bf16 v[240:255], v[72:75], v[92:95], v[240:255]
    v_mul_f32 v21, v28, v21
    v_lshlrev_b32 v22, 16, v27
    v_and_b32 v23, 0xffff0000, v27
    s_waitcnt lgkmcnt(2)
    v_mfma_f32_32x32x16_bf16 v[192:207], v[60:63], v[96:99], v[192:207]
    s_waitcnt vmcnt(18)
    ds_read_b64_tr_b16 v[68:69], v14 offset:6144
    ds_read_b64_tr_b16 v[70:71], v14 offset:7168
    v_mfma_f32_32x32x16_bf16 v[224:239], v[60:63], v[100:103], v[224:239]
    ds_read_b64_tr_b16 v[72:73], v15 offset:6144
    ds_read_b64_tr_b16 v[74:75], v15 offset:7168
    v_mul_f32 v22, v28, v22
    s_waitcnt lgkmcnt(4)
    v_mfma_f32_32x32x16_bf16 v[208:223], v[64:67], v[96:99], v[208:223]
    v_mul_f32 v23, v28, v23
    v_lshlrev_b32 v42, 1, v8
    v_xor_b32 v42, v42, v9
    v_mfma_f32_32x32x16_bf16 v[240:255], v[64:67], v[100:103], v[240:255]
    v_lshlrev_b32 v42, 4, v42
    v_lshl_add_u32 v42, v9, 8, v42
    s_lshl_b32 s32, s69, 11
    v_add_u32 v42, s32, v42
    s_waitcnt vmcnt(16) lgkmcnt(2)
    v_mfma_f32_32x32x16_bf16 v[192:207], v[68:71], v[104:107], v[192:207]
    s_waitcnt vmcnt(14)
    ds_read_b64_tr_b16 v[60:61], v14 offset:8192
    ds_read_b64_tr_b16 v[62:63], v14 offset:9216
    ds_read_b64_tr_b16 v[64:65], v15 offset:8192
    v_mfma_f32_32x32x16_bf16 v[224:239], v[68:71], v[108:111], v[224:239]
    ds_read_b64_tr_b16 v[66:67], v15 offset:9216
    v_xor_b32 v43, 16, v42
    v_add_u32 v32, 57344, v42
    s_waitcnt lgkmcnt(4)
    v_mfma_f32_32x32x16_bf16 v[208:223], v[72:75], v[104:107], v[208:223]
    v_add_u32 v33, 57344, v43
    v_xor_b32 v34, s69, v8
    v_lshlrev_b32 v34, 4, v34
    v_mfma_f32_32x32x16_bf16 v[240:255], v[72:75], v[108:111], v[240:255]
    v_lshl_add_u32 v34, v8, 10, v34
    v_lshl_add_u32 v34, v9, 1, v34
    v_add_u32 v34, 140544, v34
    s_waitcnt vmcnt(12) lgkmcnt(2)
    v_mfma_f32_32x32x16_bf16 v[192:207], v[60:63], v[112:115], v[192:207]
    s_waitcnt vmcnt(10)
    ds_read_b64_tr_b16 v[68:69], v14 offset:10240
    v_mfma_f32_32x32x16_bf16 v[224:239], v[60:63], v[116:119], v[224:239]
    ds_read_b64_tr_b16 v[70:71], v14 offset:11264
    s_waitcnt lgkmcnt(2)
    v_mfma_f32_32x32x16_bf16 v[208:223], v[64:67], v[112:115], v[208:223]
    ds_read_b64_tr_b16 v[72:73], v15 offset:10240
    v_mfma_f32_32x32x16_bf16 v[240:255], v[64:67], v[116:119], v[240:255]
    ds_read_b64_tr_b16 v[74:75], v15 offset:11264
    s_waitcnt vmcnt(8) lgkmcnt(2)
    v_mfma_f32_32x32x16_bf16 v[192:207], v[68:71], v[120:123], v[192:207]
    s_waitcnt vmcnt(6)
    ds_read_b64_tr_b16 v[60:61], v14 offset:12288
    v_mfma_f32_32x32x16_bf16 v[224:239], v[68:71], v[124:127], v[224:239]
    ds_read_b64_tr_b16 v[62:63], v14 offset:13312
    s_waitcnt lgkmcnt(2)
    v_mfma_f32_32x32x16_bf16 v[208:223], v[72:75], v[120:123], v[208:223]
    ds_read_b64_tr_b16 v[64:65], v15 offset:12288
    v_mfma_f32_32x32x16_bf16 v[240:255], v[72:75], v[124:127], v[240:255]
    ds_read_b64_tr_b16 v[66:67], v15 offset:13312
    s_waitcnt vmcnt(4) lgkmcnt(2)
    v_mfma_f32_32x32x16_bf16 v[192:207], v[60:63], v[128:131], v[192:207]
    s_waitcnt vmcnt(2)
    ds_read_b64_tr_b16 v[68:69], v14 offset:14336
    v_mfma_f32_32x32x16_bf16 v[224:239], v[60:63], v[132:135], v[224:239]
    ds_read_b64_tr_b16 v[70:71], v14 offset:15360
    s_waitcnt lgkmcnt(2)
    v_mfma_f32_32x32x16_bf16 v[208:223], v[64:67], v[128:131], v[208:223]
    ds_read_b64_tr_b16 v[72:73], v15 offset:14336
    v_mfma_f32_32x32x16_bf16 v[240:255], v[64:67], v[132:135], v[240:255]
    ds_read_b64_tr_b16 v[74:75], v15 offset:15360
    s_waitcnt vmcnt(0) lgkmcnt(2)
    v_mfma_f32_32x32x16_bf16 v[192:207], v[68:71], v[136:139], v[192:207]
    v_mfma_f32_32x32x16_bf16 v[224:239], v[68:71], v[140:143], v[224:239]
    s_waitcnt lgkmcnt(0)
    v_mfma_f32_32x32x16_bf16 v[208:223], v[72:75], v[136:139], v[208:223]
    v_mfma_f32_32x32x16_bf16 v[240:255], v[72:75], v[140:143], v[240:255]
    s_nop 7
    ds_write_b128 v44, v[192:195] offset:0
    ds_write_b128 v45, v[196:199] offset:0
    ds_write_b128 v46, v[200:203] offset:0
    ds_write_b128 v47, v[204:207] offset:0
    ds_write_b128 v44, v[224:227] offset:8192
    ds_write_b128 v45, v[228:231] offset:8192
    ds_write_b128 v46, v[232:235] offset:8192
    ds_write_b128 v47, v[236:239] offset:8192
    ds_write_b128 v44, v[208:211] offset:128
    ds_write_b128 v45, v[212:215] offset:128
    ds_write_b128 v46, v[216:219] offset:128
    ds_write_b128 v47, v[220:223] offset:128
    s_nop 3
    ds_write_b128 v44, v[240:243] offset:8320
    ds_write_b128 v45, v[244:247] offset:8320
    ds_write_b128 v46, v[248:251] offset:8320
    ds_write_b128 v47, v[252:255] offset:8320
    v_mov_b32 v56, 0
    v_mov_b32 v57, 0
    v_mov_b32 v58, 0
    v_mov_b32 v59, 0
    v_mov_b32 v60, 0
    v_mov_b32 v61, 0
    v_mov_b32 v62, 0
    v_mov_b32 v63, 0
    s_waitcnt lgkmcnt(0)
    s_barrier
    ds_read_u16_d16_hi v56, v34 offset:0
    ds_read_u16_d16_hi v57, v34 offset:128
    ds_read_u16_d16_hi v58, v34 offset:256
    ds_read_u16_d16_hi v59, v34 offset:384
    ds_read_u16_d16_hi v60, v34 offset:512
    ds_read_u16_d16_hi v61, v34 offset:640
    ds_read_u16_d16_hi v62, v34 offset:768
    ds_read_u16_d16_hi v63, v34 offset:896
    ds_read_b128 v[72:75], v42 offset:0
    ds_read_b128 v[76:79], v43 offset:0
    ds_read_b128 v[80:83], v42 offset:28672
    ds_read_b128 v[84:87], v43 offset:28672
    ds_read_b128 v[88:91], v32 offset:0
    ds_read_b128 v[92:95], v33 offset:0
    ds_read_b128 v[96:99], v32 offset:28672
    ds_read_b128 v[100:103], v33 offset:28672
    s_waitcnt lgkmcnt(15)
    v_mul_f32 v16, v16, v56
    s_waitcnt lgkmcnt(14)
    v_mul_f32 v17, v17, v57
    s_waitcnt lgkmcnt(13)
    v_mul_f32 v18, v18, v58
    s_waitcnt lgkmcnt(12)
    v_mul_f32 v19, v19, v59
    s_waitcnt lgkmcnt(11)
    v_mul_f32 v20, v20, v60
    s_waitcnt lgkmcnt(10)
    v_mul_f32 v21, v21, v61
    s_waitcnt lgkmcnt(9)
    v_mul_f32 v22, v22, v62
    s_waitcnt lgkmcnt(8)
    v_mul_f32 v23, v23, v63
    s_waitcnt lgkmcnt(0)
    v_pk_add_f32 v[72:73], v[72:73], v[80:81]
    v_pk_add_f32 v[88:89], v[88:89], v[96:97]
    v_pk_add_f32 v[74:75], v[74:75], v[82:83]
    v_pk_add_f32 v[90:91], v[90:91], v[98:99]
    v_pk_add_f32 v[76:77], v[76:77], v[84:85]
    v_pk_add_f32 v[92:93], v[92:93], v[100:101]
    v_pk_add_f32 v[78:79], v[78:79], v[86:87]
    v_pk_add_f32 v[94:95], v[94:95], v[102:103]
    v_pk_add_f32 v[72:73], v[72:73], v[88:89]
    v_pk_add_f32 v[74:75], v[74:75], v[90:91]
    v_pk_add_f32 v[76:77], v[76:77], v[92:93]
    v_pk_add_f32 v[78:79], v[78:79], v[94:95]
    v_fma_f32 v72, v72, v2, v16
    v_fma_f32 v73, v73, v2, v17
    v_fma_f32 v74, v74, v2, v18
    v_fma_f32 v75, v75, v2, v19
    v_fma_f32 v76, v76, v2, v20
    v_fma_f32 v77, v77, v2, v21
    v_fma_f32 v78, v78, v2, v22
    v_fma_f32 v79, v79, v2, v23
    v_cvt_pk_bf16_f32 v80, v72, v73
    v_cvt_pk_bf16_f32 v81, v74, v75
    v_cvt_pk_bf16_f32 v82, v76, v77
    v_cvt_pk_bf16_f32 v83, v78, v79
    buffer_store_dwordx4 v[80:83], v12, s[44:47], 0 offen sc1
    s_endpgm
gmix_phase2_kernel_conv:
    s_setprio 2
    s_and_b32 s18, s2, 7
    s_lshr_b32 s19, s2, 3
    s_mov_b32 s68, 1048576
    s_lshr_b32 s23, s24, 1
    s_and_b32 s37, s24, 1
    s_lshl_b32 s20, s18, 6
    s_lshl_b32 s21, s19, 1
    s_add_u32 s20, s20, s21
    s_add_u32 s20, s20, s23
    s_lshl_b32 s21, s20, 12
    s_lshl_b32 s31, s37, 10
    v_add_u32 v4, s31, v3
    s_lshl_b32 s31, s20, 1
    v_mov_b32 v10, s31
    v_mov_b32 v5, 156928
    v_add_u32 v5, v5, v1
    v_lshlrev_b32 v6, 2, v1
    v_add_u32 v6, 156928, v6
    v_mov_b32 v7, 0
    s_mov_b32 exec_hi, 0
    s_mov_b32 exec_lo, 0xffff
    ds_write_b32 v6, v7
    s_mov_b64 exec, -1
    s_waitcnt lgkmcnt(0)
    s_mov_b32 s48, s16
    s_mov_b32 s49, s17
    s_mov_b32 s50, 16777216
    s_mov_b32 s51, 0x00020000
    s_mov_b32 s56, s8
    s_mov_b32 s57, s9
    s_mov_b32 s58, 2097152
    s_mov_b32 s59, 0x00020000
    buffer_load_dwordx4 v[16:19], v4, s[48:51], s21 offen
    buffer_load_dwordx4 v[20:23], v4, s[48:51], s21 offen offset:2048
    buffer_load_dwordx4 v[24:27], v4, s[56:59], s21 offen
    buffer_load_dword v28, v4, s[56:59], s21 offen offset:16
    buffer_load_dwordx4 v[30:33], v4, s[56:59], s21 offen offset:2048
    buffer_load_dword v34, v4, s[56:59], s21 offen offset:2064
    s_mov_b32 s60, s10
    s_mov_b32 s61, s11
    s_mov_b32 s62, 1024
    s_mov_b32 s63, 0x00020000
    buffer_load_ushort v10, v10, s[60:63], 0 offen
    s_barrier
    s_mov_b32 s40, s4
    s_mov_b32 s41, s5
    s_mov_b32 s42, 2097152
    s_mov_b32 s43, 0x00020000
    s_mov_b32 s44, s12
    s_mov_b32 s45, s13
    s_mov_b32 s46, 2097152
    s_mov_b32 s47, 0x00020000
    v_and_b32 v58, 15, v1
    v_lshrrev_b32 v59, 4, v1
    s_mul_i32 s36, s23, 12928
    s_add_u32 s36, s36, 114688
    s_lshl_b32 s33, s37, 8
    v_lshlrev_b32 v13, 3, v59
    v_sub_u32 v13, v58, v13
    v_add_u32 v13, 25, v13
    v_and_b32 v14, 1, v13
    v_mul_u32_u24 v14, 4160, v14
    v_lshrrev_b32 v13, 1, v13
    v_lshl_add_u32 v13, v13, 2, v14
    s_add_u32 s32, s36, s33
    s_add_u32 s32, s32, 4608
    v_add_u32 v48, s32, v13
    v_lshlrev_b32 v13, 5, v58
    v_lshl_add_u32 v13, v59, 4, v13
    s_sub_u32 s32, s36, s33
    s_add_u32 s32, s32, 480
    v_add_u32 v52, s32, v13
    v_add_u32 v49, 1024, v48
    v_add_u32 v50, 2048, v48
    v_add_u32 v51, 3072, v48
    v_add_u32 v11, s36, v4
    v_mov_b32 v40, 0
    v_mov_b32 v41, 0
    v_mov_b32 v42, 0
    v_mov_b32 v43, 0
    v_mov_b32 v44, 0
    v_mov_b32 v45, 0
    v_mov_b32 v46, 0
    s_lshl_b32 s32, s24, 2
    s_add_u32 s32, s32, 156928
    v_mov_b32 v5, s32
    s_xor_b32 s32, s32, 4
    v_mov_b32 v6, s32
    v_mov_b32 v7, 1
    s_waitcnt vmcnt(6)
    ds_write_b128 v11, v[16:19] offset:512
    s_waitcnt vmcnt(5)
    ds_write_b128 v11, v[20:23] offset:2560
    s_waitcnt vmcnt(3)
    v_alignbit_b32 v36, v25, v24, 16
    v_alignbit_b32 v37, v26, v25, 16
    v_alignbit_b32 v38, v27, v26, 16
    v_alignbit_b32 v39, v28, v27, 16
    ds_write_b128 v11, v[24:27] offset:4640
    ds_write_b128 v11, v[36:39] offset:8800
    s_waitcnt vmcnt(1)
    v_alignbit_b32 v36, v31, v30, 16
    v_alignbit_b32 v37, v32, v31, 16
    v_alignbit_b32 v38, v33, v32, 16
    v_alignbit_b32 v39, v34, v33, 16
    ds_write_b128 v11, v[30:33] offset:6688
    ds_write_b128 v11, v[36:39] offset:10848
    s_cmp_lg_u32 s37, 0
    s_cbranch_scc1 gmix_phase2_kernel_nz
    s_mov_b32 exec_hi, 0
    ds_write_b128 v11, v[40:43] offset:0
    s_mov_b32 exec_lo, 1
    v_lshlrev_b32 v47, 16, v24
    ds_write_b128 v11, v[40:43] offset:4608
    ds_write_b128 v11, v[40:43] offset:4624
    ds_write_b128 v11, v[40:43] offset:8768
    ds_write_b128 v11, v[44:47] offset:8784
    s_mov_b64 exec, -1
gmix_phase2_kernel_nz:
    s_waitcnt lgkmcnt(0)
    ds_write_b32 v5, v7 offset:0
gmix_phase2_kernel_hs0:
    ds_read_b32 v13, v6 offset:0
    s_waitcnt lgkmcnt(0)
    v_readfirstlane_b32 s32, v13
    s_nop 0
    s_sub_u32 s68, s68, 1
    s_cmp_eq_u32 s68, 0
    s_cselect_b32 s32, 1, s32
    s_cmp_eq_u32 s32, 0
    s_cbranch_scc1 gmix_phase2_kernel_hs0
    ds_read_b128 v[96:99], v52 offset:0
    ds_read2_b32 v[64:65], v48 offset0:0 offset1:1
    ds_read2_b32 v[66:67], v48 offset0:2 offset1:3
    ds_read_b128 v[100:103], v52 offset:512
    ds_read2_b32 v[68:69], v48 offset0:128 offset1:129
    ds_read2_b32 v[70:71], v48 offset0:130 offset1:131
    ds_read_b128 v[104:107], v52 offset:1024
    ds_read2_b32 v[72:73], v49 offset0:0 offset1:1
    ds_read2_b32 v[74:75], v49 offset0:2 offset1:3
    ds_read_b128 v[108:111], v52 offset:1536
    ds_read2_b32 v[76:77], v49 offset0:128 offset1:129
    ds_read2_b32 v[78:79], v49 offset0:130 offset1:131
    ds_read_b128 v[112:115], v52 offset:2048
    ds_read2_b32 v[80:81], v50 offset0:0 offset1:1
    ds_read2_b32 v[82:83], v50 offset0:2 offset1:3
    ds_read_b128 v[116:119], v52 offset:2560
    ds_read2_b32 v[84:85], v50 offset0:128 offset1:129
    ds_read2_b32 v[86:87], v50 offset0:130 offset1:131
    ds_read_b128 v[120:123], v52 offset:3072
    ds_read2_b32 v[88:89], v51 offset0:0 offset1:1
    ds_read2_b32 v[90:91], v51 offset0:2 offset1:3
    ds_read_b128 v[124:127], v52 offset:3584
    ds_read2_b32 v[92:93], v51 offset0:128 offset1:129
    ds_read2_b32 v[94:95], v51 offset0:130 offset1:131
    s_waitcnt lgkmcnt(15)
    v_mfma_f32_16x16x32_bf16 v[192:195], v[64:67], v[96:99], 0
    v_mfma_f32_16x16x32_bf16 v[196:199], v[64:67], v[100:103], 0
    v_add_u32 v48, 64, v48
    v_mfma_f32_16x16x32_bf16 v[200:203], v[64:67], v[104:107], 0
    v_add_u32 v49, 64, v49
    s_waitcnt lgkmcnt(14)
    v_mfma_f32_16x16x32_bf16 v[204:207], v[64:67], v[108:111], 0
    v_add_u32 v50, 64, v50
    s_waitcnt lgkmcnt(11)
    v_mfma_f32_16x16x32_bf16 v[208:211], v[64:67], v[112:115], 0
    v_add_u32 v51, 64, v51
    s_waitcnt lgkmcnt(8)
    v_mfma_f32_16x16x32_bf16 v[212:215], v[64:67], v[116:119], 0
    v_subrev_u32 v52, 64, v52
    s_waitcnt lgkmcnt(5)
    v_mfma_f32_16x16x32_bf16 v[216:219], v[64:67], v[120:123], 0
    ds_read_b128 v[160:163], v52 offset:0
    s_waitcnt lgkmcnt(3)
    v_mfma_f32_16x16x32_bf16 v[220:223], v[64:67], v[124:127], 0
    ds_read2_b32 v[128:129], v48 offset0:0 offset1:1
    v_mfma_f32_16x16x32_bf16 v[196:199], v[68:71], v[96:99], v[196:199]
    ds_read2_b32 v[130:131], v48 offset0:2 offset1:3
    v_mfma_f32_16x16x32_bf16 v[200:203], v[68:71], v[100:103], v[200:203]
    ds_read_b128 v[164:167], v52 offset:512
    v_mfma_f32_16x16x32_bf16 v[204:207], v[68:71], v[104:107], v[204:207]
    ds_read2_b32 v[132:133], v48 offset0:128 offset1:129
    v_mfma_f32_16x16x32_bf16 v[208:211], v[68:71], v[108:111], v[208:211]
    ds_read2_b32 v[134:135], v48 offset0:130 offset1:131
    v_mfma_f32_16x16x32_bf16 v[212:215], v[68:71], v[112:115], v[212:215]
    ds_read_b128 v[168:171], v52 offset:1024
    v_mfma_f32_16x16x32_bf16 v[216:219], v[68:71], v[116:119], v[216:219]
    ds_read2_b32 v[136:137], v49 offset0:0 offset1:1
    v_mfma_f32_16x16x32_bf16 v[220:223], v[68:71], v[120:123], v[220:223]
    ds_read2_b32 v[138:139], v49 offset0:2 offset1:3
    v_mfma_f32_16x16x32_bf16 v[200:203], v[72:75], v[96:99], v[200:203]
    ds_read_b128 v[172:175], v52 offset:1536
    v_mfma_f32_16x16x32_bf16 v[204:207], v[72:75], v[100:103], v[204:207]
    ds_read2_b32 v[140:141], v49 offset0:128 offset1:129
    v_mfma_f32_16x16x32_bf16 v[208:211], v[72:75], v[104:107], v[208:211]
    ds_read2_b32 v[142:143], v49 offset0:130 offset1:131
    v_mfma_f32_16x16x32_bf16 v[212:215], v[72:75], v[108:111], v[212:215]
    v_mfma_f32_16x16x32_bf16 v[216:219], v[72:75], v[112:115], v[216:219]
    ds_read_b128 v[176:179], v52 offset:2048
    v_mfma_f32_16x16x32_bf16 v[220:223], v[72:75], v[116:119], v[220:223]
    ds_read2_b32 v[144:145], v50 offset0:0 offset1:1
    v_mfma_f32_16x16x32_bf16 v[204:207], v[76:79], v[96:99], v[204:207]
    ds_read2_b32 v[146:147], v50 offset0:2 offset1:3
    v_mfma_f32_16x16x32_bf16 v[208:211], v[76:79], v[100:103], v[208:211]
    ds_read_b128 v[180:183], v52 offset:2560
    v_mfma_f32_16x16x32_bf16 v[212:215], v[76:79], v[104:107], v[212:215]
    ds_read2_b32 v[148:149], v50 offset0:128 offset1:129
    v_mfma_f32_16x16x32_bf16 v[216:219], v[76:79], v[108:111], v[216:219]
    ds_read2_b32 v[150:151], v50 offset0:130 offset1:131
    v_mfma_f32_16x16x32_bf16 v[220:223], v[76:79], v[112:115], v[220:223]
    ds_read_b128 v[184:187], v52 offset:3072
    v_mfma_f32_16x16x32_bf16 v[208:211], v[80:83], v[96:99], v[208:211]
    ds_read2_b32 v[152:153], v51 offset0:0 offset1:1
    v_mfma_f32_16x16x32_bf16 v[212:215], v[80:83], v[100:103], v[212:215]
    ds_read2_b32 v[154:155], v51 offset0:2 offset1:3
    v_mfma_f32_16x16x32_bf16 v[216:219], v[80:83], v[104:107], v[216:219]
    ds_read_b128 v[188:191], v52 offset:3584
    v_mfma_f32_16x16x32_bf16 v[220:223], v[80:83], v[108:111], v[220:223]
    ds_read2_b32 v[156:157], v51 offset0:128 offset1:129
    v_mfma_f32_16x16x32_bf16 v[212:215], v[84:87], v[96:99], v[212:215]
    ds_read2_b32 v[158:159], v51 offset0:130 offset1:131
    v_mfma_f32_16x16x32_bf16 v[216:219], v[84:87], v[100:103], v[216:219]
    s_lshl_b32 s32, s24, 12
    s_add_u32 s32, s32, 140544
    v_add_u32 v53, s32, v3
    s_xor_b32 s32, s32, 4096
    v_add_u32 v54, s32, v3
    v_mfma_f32_16x16x32_bf16 v[220:223], v[84:87], v[104:107], v[220:223]
    v_xor_b32 v55, 1, v59
    v_mfma_f32_16x16x32_bf16 v[216:219], v[88:91], v[96:99], v[216:219]
    v_lshlrev_b32 v55, 3, v55
    v_mfma_f32_16x16x32_bf16 v[220:223], v[88:91], v[100:103], v[220:223]
    v_lshl_add_u32 v55, v58, 5, v55
    s_waitcnt lgkmcnt(15)
    v_mfma_f32_16x16x32_bf16 v[220:223], v[92:95], v[96:99], v[220:223]
    s_lshl_b32 s33, s37, 11
    s_add_u32 s32, s36, s33
    s_add_u32 s32, s32, 512
    v_add_u32 v55, s32, v55
    s_add_u32 s38, s21, s33
    s_add_u32 s38, s38, 2097152
    v_mfma_f32_16x16x32_bf16 v[192:195], v[128:131], v[160:163], v[192:195]
    v_mfma_f32_16x16x32_bf16 v[196:199], v[128:131], v[164:167], v[196:199]
    v_add_u32 v48, 64, v48
    v_mfma_f32_16x16x32_bf16 v[200:203], v[128:131], v[168:171], v[200:203]
    v_add_u32 v49, 64, v49
    s_waitcnt lgkmcnt(14)
    v_mfma_f32_16x16x32_bf16 v[204:207], v[128:131], v[172:175], v[204:207]
    v_add_u32 v50, 64, v50
    s_waitcnt lgkmcnt(11)
    v_mfma_f32_16x16x32_bf16 v[208:211], v[128:131], v[176:179], v[208:211]
    v_add_u32 v51, 64, v51
    s_waitcnt lgkmcnt(8)
    v_mfma_f32_16x16x32_bf16 v[212:215], v[128:131], v[180:183], v[212:215]
    v_subrev_u32 v52, 64, v52
    s_waitcnt lgkmcnt(5)
    v_mfma_f32_16x16x32_bf16 v[216:219], v[128:131], v[184:187], v[216:219]
    ds_read_b128 v[96:99], v52 offset:0
    s_waitcnt lgkmcnt(3)
    v_mfma_f32_16x16x32_bf16 v[220:223], v[128:131], v[188:191], v[220:223]
    ds_read2_b32 v[64:65], v48 offset0:0 offset1:1
    v_mfma_f32_16x16x32_bf16 v[196:199], v[132:135], v[160:163], v[196:199]
    ds_read2_b32 v[66:67], v48 offset0:2 offset1:3
    v_mfma_f32_16x16x32_bf16 v[200:203], v[132:135], v[164:167], v[200:203]
    v_mfma_f32_16x16x32_bf16 v[204:207], v[132:135], v[168:171], v[204:207]
    ds_read_b128 v[100:103], v52 offset:512
    v_mfma_f32_16x16x32_bf16 v[208:211], v[132:135], v[172:175], v[208:211]
    ds_read2_b32 v[68:69], v48 offset0:128 offset1:129
    v_mfma_f32_16x16x32_bf16 v[212:215], v[132:135], v[176:179], v[212:215]
    ds_read2_b32 v[70:71], v48 offset0:130 offset1:131
    v_mfma_f32_16x16x32_bf16 v[216:219], v[132:135], v[180:183], v[216:219]
    ds_read_b128 v[104:107], v52 offset:1024
    v_mfma_f32_16x16x32_bf16 v[220:223], v[132:135], v[184:187], v[220:223]
    ds_read2_b32 v[72:73], v49 offset0:0 offset1:1
    v_mfma_f32_16x16x32_bf16 v[200:203], v[136:139], v[160:163], v[200:203]
    ds_read2_b32 v[74:75], v49 offset0:2 offset1:3
    v_mfma_f32_16x16x32_bf16 v[204:207], v[136:139], v[164:167], v[204:207]
    ds_read_b128 v[108:111], v52 offset:1536
    v_mfma_f32_16x16x32_bf16 v[208:211], v[136:139], v[168:171], v[208:211]
    ds_read2_b32 v[76:77], v49 offset0:128 offset1:129
    v_mfma_f32_16x16x32_bf16 v[212:215], v[136:139], v[172:175], v[212:215]
    v_mfma_f32_16x16x32_bf16 v[216:219], v[136:139], v[176:179], v[216:219]
    ds_read2_b32 v[78:79], v49 offset0:130 offset1:131
    v_mfma_f32_16x16x32_bf16 v[220:223], v[136:139], v[180:183], v[220:223]
    ds_read_b128 v[112:115], v52 offset:2048
    v_mfma_f32_16x16x32_bf16 v[204:207], v[140:143], v[160:163], v[204:207]
    ds_read2_b32 v[80:81], v50 offset0:0 offset1:1
    v_mfma_f32_16x16x32_bf16 v[208:211], v[140:143], v[164:167], v[208:211]
    ds_read2_b32 v[82:83], v50 offset0:2 offset1:3
    v_mfma_f32_16x16x32_bf16 v[212:215], v[140:143], v[168:171], v[212:215]
    ds_read_b128 v[116:119], v52 offset:2560
    v_mfma_f32_16x16x32_bf16 v[216:219], v[140:143], v[172:175], v[216:219]
    ds_read2_b32 v[84:85], v50 offset0:128 offset1:129
    v_mfma_f32_16x16x32_bf16 v[220:223], v[140:143], v[176:179], v[220:223]
    ds_read2_b32 v[86:87], v50 offset0:130 offset1:131
    v_mfma_f32_16x16x32_bf16 v[208:211], v[144:147], v[160:163], v[208:211]
    ds_read_b128 v[120:123], v52 offset:3072
    v_mfma_f32_16x16x32_bf16 v[212:215], v[144:147], v[164:167], v[212:215]
    v_mfma_f32_16x16x32_bf16 v[216:219], v[144:147], v[168:171], v[216:219]
    ds_read2_b32 v[88:89], v51 offset0:0 offset1:1
    v_mfma_f32_16x16x32_bf16 v[220:223], v[144:147], v[172:175], v[220:223]
    ds_read2_b32 v[90:91], v51 offset0:2 offset1:3
    v_mfma_f32_16x16x32_bf16 v[212:215], v[148:151], v[160:163], v[212:215]
    ds_read_b128 v[124:127], v52 offset:3584
    v_mfma_f32_16x16x32_bf16 v[216:219], v[148:151], v[164:167], v[216:219]
    ds_read2_b32 v[92:93], v51 offset0:128 offset1:129
    v_mfma_f32_16x16x32_bf16 v[220:223], v[148:151], v[168:171], v[220:223]
    ds_read2_b32 v[94:95], v51 offset0:130 offset1:131
    v_mfma_f32_16x16x32_bf16 v[216:219], v[152:155], v[160:163], v[216:219]
    v_lshlrev_b32 v14, 5, v58
    v_mfma_f32_16x16x32_bf16 v[220:223], v[152:155], v[164:167], v[220:223]
    v_lshl_add_u32 v14, v59, 3, v14
    s_waitcnt lgkmcnt(15)
    v_mfma_f32_16x16x32_bf16 v[220:223], v[156:159], v[160:163], v[220:223]
    s_lshl_b32 s33, s25, 6
    s_lshl_b32 s35, s69, 3
    s_add_u32 s33, s33, s35
    v_add_u32 v12, s33, v9
    v_lshlrev_b32 v13, 2, v12
    v_add_u32 v13, 4194304, v13
    v_mfma_f32_16x16x32_bf16 v[192:195], v[64:67], v[96:99], v[192:195]
    v_mfma_f32_16x16x32_bf16 v[196:199], v[64:67], v[100:103], v[196:199]
    v_add_u32 v48, 64, v48
    v_mfma_f32_16x16x32_bf16 v[200:203], v[64:67], v[104:107], v[200:203]
    v_add_u32 v49, 64, v49
    s_waitcnt lgkmcnt(14)
    v_mfma_f32_16x16x32_bf16 v[204:207], v[64:67], v[108:111], v[204:207]
    v_add_u32 v50, 64, v50
    s_waitcnt lgkmcnt(11)
    v_mfma_f32_16x16x32_bf16 v[208:211], v[64:67], v[112:115], v[208:211]
    v_add_u32 v51, 64, v51
    s_waitcnt lgkmcnt(8)
    v_mfma_f32_16x16x32_bf16 v[212:215], v[64:67], v[116:119], v[212:215]
    v_subrev_u32 v52, 64, v52
    s_waitcnt lgkmcnt(5)
    v_mfma_f32_16x16x32_bf16 v[216:219], v[64:67], v[120:123], v[216:219]
    ds_read_b128 v[160:163], v52 offset:0
    s_waitcnt lgkmcnt(3)
    v_mfma_f32_16x16x32_bf16 v[220:223], v[64:67], v[124:127], v[220:223]
    ds_read2_b32 v[128:129], v48 offset0:0 offset1:1
    v_mfma_f32_16x16x32_bf16 v[196:199], v[68:71], v[96:99], v[196:199]
    ds_read2_b32 v[130:131], v48 offset0:2 offset1:3
    v_mfma_f32_16x16x32_bf16 v[200:203], v[68:71], v[100:103], v[200:203]
    ds_read_b128 v[164:167], v52 offset:512
    v_mfma_f32_16x16x32_bf16 v[204:207], v[68:71], v[104:107], v[204:207]
    ds_read2_b32 v[132:133], v48 offset0:128 offset1:129
    v_mfma_f32_16x16x32_bf16 v[208:211], v[68:71], v[108:111], v[208:211]
    ds_read2_b32 v[134:135], v48 offset0:130 offset1:131
    v_mfma_f32_16x16x32_bf16 v[212:215], v[68:71], v[112:115], v[212:215]
    ds_read_b128 v[168:171], v52 offset:1024
    v_mfma_f32_16x16x32_bf16 v[216:219], v[68:71], v[116:119], v[216:219]
    ds_read2_b32 v[136:137], v49 offset0:0 offset1:1
    v_mfma_f32_16x16x32_bf16 v[220:223], v[68:71], v[120:123], v[220:223]
    ds_read2_b32 v[138:139], v49 offset0:2 offset1:3
    v_mfma_f32_16x16x32_bf16 v[200:203], v[72:75], v[96:99], v[200:203]
    ds_read_b128 v[172:175], v52 offset:1536
    v_mfma_f32_16x16x32_bf16 v[204:207], v[72:75], v[100:103], v[204:207]
    ds_read2_b32 v[140:141], v49 offset0:128 offset1:129
    v_mfma_f32_16x16x32_bf16 v[208:211], v[72:75], v[104:107], v[208:211]
    ds_read2_b32 v[142:143], v49 offset0:130 offset1:131
    v_mfma_f32_16x16x32_bf16 v[212:215], v[72:75], v[108:111], v[212:215]
    v_mfma_f32_16x16x32_bf16 v[216:219], v[72:75], v[112:115], v[216:219]
    ds_read_b128 v[176:179], v52 offset:2048
    v_mfma_f32_16x16x32_bf16 v[220:223], v[72:75], v[116:119], v[220:223]
    ds_read2_b32 v[144:145], v50 offset0:0 offset1:1
    v_mfma_f32_16x16x32_bf16 v[204:207], v[76:79], v[96:99], v[204:207]
    ds_read2_b32 v[146:147], v50 offset0:2 offset1:3
    v_mfma_f32_16x16x32_bf16 v[208:211], v[76:79], v[100:103], v[208:211]
    ds_read_b128 v[180:183], v52 offset:2560
    v_mfma_f32_16x16x32_bf16 v[212:215], v[76:79], v[104:107], v[212:215]
    ds_read2_b32 v[148:149], v50 offset0:128 offset1:129
    v_mfma_f32_16x16x32_bf16 v[216:219], v[76:79], v[108:111], v[216:219]
    ds_read2_b32 v[150:151], v50 offset0:130 offset1:131
    v_mfma_f32_16x16x32_bf16 v[220:223], v[76:79], v[112:115], v[220:223]
    ds_read_b128 v[184:187], v52 offset:3072
    v_mfma_f32_16x16x32_bf16 v[208:211], v[80:83], v[96:99], v[208:211]
    ds_read2_b32 v[152:153], v51 offset0:0 offset1:1
    v_mfma_f32_16x16x32_bf16 v[212:215], v[80:83], v[100:103], v[212:215]
    ds_read2_b32 v[154:155], v51 offset0:2 offset1:3
    v_mfma_f32_16x16x32_bf16 v[216:219], v[80:83], v[104:107], v[216:219]
    ds_read_b128 v[188:191], v52 offset:3584
    v_mfma_f32_16x16x32_bf16 v[220:223], v[80:83], v[108:111], v[220:223]
    ds_read2_b32 v[156:157], v51 offset0:128 offset1:129
    v_mfma_f32_16x16x32_bf16 v[212:215], v[84:87], v[96:99], v[212:215]
    ds_read2_b32 v[158:159], v51 offset0:130 offset1:131
    v_mfma_f32_16x16x32_bf16 v[216:219], v[84:87], v[100:103], v[216:219]
    v_lshlrev_b32 v12, 10, v12
    v_mfma_f32_16x16x32_bf16 v[220:223], v[84:87], v[104:107], v[220:223]
    v_lshl_add_u32 v12, v8, 4, v12
    v_mfma_f32_16x16x32_bf16 v[216:219], v[88:91], v[96:99], v[216:219]
    v_add_u32 v12, s34, v12
    v_mfma_f32_16x16x32_bf16 v[220:223], v[88:91], v[100:103], v[220:223]
    buffer_load_dwordx4 v[24:27], v12, s[40:43], 0 offen
    s_waitcnt lgkmcnt(15)
    v_mfma_f32_16x16x32_bf16 v[220:223], v[92:95], v[96:99], v[220:223]
    buffer_load_dword v28, v13, s[48:51], 0 offen
    v_mfma_f32_16x16x32_bf16 v[192:195], v[128:131], v[160:163], v[192:195]
    v_mfma_f32_16x16x32_bf16 v[196:199], v[128:131], v[164:167], v[196:199]
    v_mfma_f32_16x16x32_bf16 v[200:203], v[128:131], v[168:171], v[200:203]
    s_waitcnt lgkmcnt(14)
    v_mfma_f32_16x16x32_bf16 v[204:207], v[128:131], v[172:175], v[204:207]
    s_waitcnt lgkmcnt(11)
    v_mfma_f32_16x16x32_bf16 v[208:211], v[128:131], v[176:179], v[208:211]
    s_waitcnt lgkmcnt(8)
    v_mfma_f32_16x16x32_bf16 v[212:215], v[128:131], v[180:183], v[212:215]
    s_waitcnt lgkmcnt(5)
    v_mfma_f32_16x16x32_bf16 v[216:219], v[128:131], v[184:187], v[216:219]
    s_waitcnt lgkmcnt(2)
    v_mfma_f32_16x16x32_bf16 v[220:223], v[128:131], v[188:191], v[220:223]
    v_mfma_f32_16x16x32_bf16 v[196:199], v[132:135], v[160:163], v[196:199]
    v_mfma_f32_16x16x32_bf16 v[200:203], v[132:135], v[164:167], v[200:203]
    v_mfma_f32_16x16x32_bf16 v[204:207], v[132:135], v[168:171], v[204:207]
    v_mfma_f32_16x16x32_bf16 v[208:211], v[132:135], v[172:175], v[208:211]
    v_mfma_f32_16x16x32_bf16 v[212:215], v[132:135], v[176:179], v[212:215]
    v_mfma_f32_16x16x32_bf16 v[216:219], v[132:135], v[180:183], v[216:219]
    v_mfma_f32_16x16x32_bf16 v[220:223], v[132:135], v[184:187], v[220:223]
    v_mfma_f32_16x16x32_bf16 v[200:203], v[136:139], v[160:163], v[200:203]
    v_mfma_f32_16x16x32_bf16 v[204:207], v[136:139], v[164:167], v[204:207]
    v_mfma_f32_16x16x32_bf16 v[208:211], v[136:139], v[168:171], v[208:211]
    v_mfma_f32_16x16x32_bf16 v[212:215], v[136:139], v[172:175], v[212:215]
    v_mfma_f32_16x16x32_bf16 v[216:219], v[136:139], v[176:179], v[216:219]
    v_mfma_f32_16x16x32_bf16 v[220:223], v[136:139], v[180:183], v[220:223]
    v_mfma_f32_16x16x32_bf16 v[204:207], v[140:143], v[160:163], v[204:207]
    v_mfma_f32_16x16x32_bf16 v[208:211], v[140:143], v[164:167], v[208:211]
    v_mfma_f32_16x16x32_bf16 v[212:215], v[140:143], v[168:171], v[212:215]
    v_mfma_f32_16x16x32_bf16 v[216:219], v[140:143], v[172:175], v[216:219]
    v_mfma_f32_16x16x32_bf16 v[220:223], v[140:143], v[176:179], v[220:223]
    v_mfma_f32_16x16x32_bf16 v[208:211], v[144:147], v[160:163], v[208:211]
    v_mfma_f32_16x16x32_bf16 v[212:215], v[144:147], v[164:167], v[212:215]
    v_mfma_f32_16x16x32_bf16 v[216:219], v[144:147], v[168:171], v[216:219]
    v_mfma_f32_16x16x32_bf16 v[220:223], v[144:147], v[172:175], v[220:223]
    v_mfma_f32_16x16x32_bf16 v[212:215], v[148:151], v[160:163], v[212:215]
    v_mfma_f32_16x16x32_bf16 v[216:219], v[148:151], v[164:167], v[216:219]
    v_mfma_f32_16x16x32_bf16 v[220:223], v[148:151], v[168:171], v[220:223]
    v_mfma_f32_16x16x32_bf16 v[216:219], v[152:155], v[160:163], v[216:219]
    v_mfma_f32_16x16x32_bf16 v[220:223], v[152:155], v[164:167], v[220:223]
    s_waitcnt lgkmcnt(0)
    v_mfma_f32_16x16x32_bf16 v[220:223], v[156:159], v[160:163], v[220:223]
    ds_read_b64 v[80:81], v55 offset:0
    ds_read_b64 v[82:83], v55 offset:512
    ds_read_b64 v[84:85], v55 offset:1024
    ds_read_b64 v[86:87], v55 offset:1536
    s_waitcnt vmcnt(2)
    v_lshlrev_b32 v10, 16, v10
    s_nop 2
    s_cmp_eq_u32 s37, 1
    s_cbranch_scc1 gmix_phase2_kernel_hi
    ds_write_b128 v53, v[208:211] offset:0
    ds_write_b128 v53, v[212:215] offset:1024
    ds_write_b128 v53, v[216:219] offset:2048
    ds_write_b128 v53, v[220:223] offset:3072
    v_mov_b32 v224, v192
    v_mov_b32 v225, v193
    v_mov_b32 v226, v194
    v_mov_b32 v227, v195
    v_mov_b32 v228, v196
    v_mov_b32 v229, v197
    v_mov_b32 v230, v198
    v_mov_b32 v231, v199
    v_mov_b32 v232, v200
    v_mov_b32 v233, v201
    v_mov_b32 v234, v202
    v_mov_b32 v235, v203
    v_mov_b32 v236, v204
    v_mov_b32 v237, v205
    v_mov_b32 v238, v206
    v_mov_b32 v239, v207
    s_branch gmix_phase2_kernel_rj
gmix_phase2_kernel_hi:
    ds_write_b128 v53, v[192:195] offset:0
    ds_write_b128 v53, v[196:199] offset:1024
    ds_write_b128 v53, v[200:203] offset:2048
    ds_write_b128 v53, v[204:207] offset:3072
    v_mov_b32 v224, v208
    v_mov_b32 v225, v209
    v_mov_b32 v226, v210
    v_mov_b32 v227, v211
    v_mov_b32 v228, v212
    v_mov_b32 v229, v213
    v_mov_b32 v230, v214
    v_mov_b32 v231, v215
    v_mov_b32 v232, v216
    v_mov_b32 v233, v217
    v_mov_b32 v234, v218
    v_mov_b32 v235, v219
    v_mov_b32 v236, v220
    v_mov_b32 v237, v221
    v_mov_b32 v238, v222
    v_mov_b32 v239, v223
gmix_phase2_kernel_rj:
    s_waitcnt lgkmcnt(0)
    ds_write_b32 v5, v7 offset:16
gmix_phase2_kernel_hs1:
    ds_read_b32 v13, v6 offset:16
    s_waitcnt lgkmcnt(0)
    v_readfirstlane_b32 s32, v13
    s_nop 0
    s_sub_u32 s68, s68, 1
    s_cmp_eq_u32 s68, 0
    s_cselect_b32 s32, 1, s32
    s_cmp_eq_u32 s32, 0
    s_cbranch_scc1 gmix_phase2_kernel_hs1
    ds_read_b128 v[64:67], v54 offset:0
    ds_read_b128 v[68:71], v54 offset:1024
    ds_read_b128 v[72:75], v54 offset:2048
    ds_read_b128 v[76:79], v54 offset:3072
    v_and_b32 v240, 0xffff0000, v81
    v_lshlrev_b32 v241, 16, v81
    v_and_b32 v242, 0xffff0000, v80
    v_lshlrev_b32 v243, 16, v80
    v_fmac_f32 v224, v240, v10
    v_fmac_f32 v225, v241, v10
    v_fmac_f32 v226, v242, v10
    v_fmac_f32 v227, v243, v10
    s_waitcnt lgkmcnt(3)
    v_pk_add_f32 v[224:225], v[224:225], v[64:65]
    v_pk_add_f32 v[226:227], v[226:227], v[66:67]
    v_cvt_pk_bf16_f32 v96, v224, v225
    v_cvt_pk_bf16_f32 v97, v226, v227
    buffer_store_dwordx2 v[96:97], v14, s[48:51], s38 offen offset:0 sc1
    v_and_b32 v240, 0xffff0000, v83
    v_lshlrev_b32 v241, 16, v83
    v_and_b32 v242, 0xffff0000, v82
    v_lshlrev_b32 v243, 16, v82
    v_fmac_f32 v228, v240, v10
    v_fmac_f32 v229, v241, v10
    v_fmac_f32 v230, v242, v10
    v_fmac_f32 v231, v243, v10
    s_waitcnt lgkmcnt(2)
    v_pk_add_f32 v[228:229], v[228:229], v[68:69]
    v_pk_add_f32 v[230:231], v[230:231], v[70:71]
    v_cvt_pk_bf16_f32 v98, v228, v229
    v_cvt_pk_bf16_f32 v99, v230, v231
    buffer_store_dwordx2 v[98:99], v14, s[48:51], s38 offen offset:512 sc1
    v_and_b32 v240, 0xffff0000, v85
    v_lshlrev_b32 v241, 16, v85
    v_and_b32 v242, 0xffff0000, v84
    v_lshlrev_b32 v243, 16, v84
    v_fmac_f32 v232, v240, v10
    v_fmac_f32 v233, v241, v10
    v_fmac_f32 v234, v242, v10
    v_fmac_f32 v235, v243, v10
    s_waitcnt lgkmcnt(1)
    v_pk_add_f32 v[232:233], v[232:233], v[72:73]
    v_pk_add_f32 v[234:235], v[234:235], v[74:75]
    v_cvt_pk_bf16_f32 v100, v232, v233
    v_cvt_pk_bf16_f32 v101, v234, v235
    buffer_store_dwordx2 v[100:101], v14, s[48:51], s38 offen offset:1024 sc1
    v_and_b32 v240, 0xffff0000, v87
    v_lshlrev_b32 v241, 16, v87
    v_and_b32 v242, 0xffff0000, v86
    v_lshlrev_b32 v243, 16, v86
    v_fmac_f32 v236, v240, v10
    v_fmac_f32 v237, v241, v10
    v_fmac_f32 v238, v242, v10
    v_fmac_f32 v239, v243, v10
    s_waitcnt lgkmcnt(0)
    v_pk_add_f32 v[236:237], v[236:237], v[76:77]
    v_pk_add_f32 v[238:239], v[238:239], v[78:79]
    v_cvt_pk_bf16_f32 v102, v236, v237
    v_cvt_pk_bf16_f32 v103, v238, v239
    buffer_store_dwordx2 v[102:103], v14, s[48:51], s38 offen offset:1536 sc1
    ds_write_b32 v5, v7 offset:32
    s_waitcnt vmcnt(4)
    v_sub_f32 v2, 1.0, v28
    v_cvt_pk_bf16_f32 v2, v2, v2
    v_lshlrev_b32 v2, 16, v2
    v_lshlrev_b32 v16, 16, v24
    v_and_b32 v17, 0xffff0000, v24
    v_mul_f32 v16, v28, v16
    v_mul_f32 v17, v28, v17
    v_lshlrev_b32 v18, 16, v25
    v_and_b32 v19, 0xffff0000, v25
    v_mul_f32 v18, v28, v18
    v_mul_f32 v19, v28, v19
    v_lshlrev_b32 v20, 16, v26
    v_and_b32 v21, 0xffff0000, v26
    v_mul_f32 v20, v28, v20
    v_mul_f32 v21, v28, v21
    v_lshlrev_b32 v22, 16, v27
    v_and_b32 v23, 0xffff0000, v27
    v_mul_f32 v22, v28, v22
    v_mul_f32 v23, v28, v23
    v_lshlrev_b32 v42, 1, v8
    v_xor_b32 v42, v42, v9
    v_lshlrev_b32 v42, 4, v42
    v_lshl_add_u32 v42, v9, 8, v42
    s_lshl_b32 s32, s69, 11
    v_add_u32 v42, s32, v42
    v_xor_b32 v43, 16, v42
    v_add_u32 v32, 57344, v42
    v_add_u32 v33, 57344, v43
    v_xor_b32 v34, s69, v8
    v_lshlrev_b32 v34, 4, v34
    v_lshl_add_u32 v34, v8, 10, v34
    v_lshl_add_u32 v34, v9, 1, v34
    v_add_u32 v34, 140544, v34
    s_lshl_b32 s31, s24, 1
    s_lshl_b32 s32, s26, 6
    s_lshl_b32 s33, s31, 3
    s_add_u32 s32, s32, s33
    s_lshl_b32 s32, s32, 12
    s_lshl_b32 s33, s25, 7
    s_add_u32 s32, s32, s33
    s_add_u32 s39, s32, 2097152
    s_add_u32 s38, s39, 32768
    v_lshlrev_b32 v10, 4, v8
    v_lshl_add_u32 v10, v9, 12, v10
    v_xor_b32 v11, s31, v8
    v_lshlrev_b32 v11, 4, v11
    v_lshl_add_u32 v11, v9, 7, v11
    s_lshl_b32 s33, s31, 10
    s_add_u32 s33, s33, 140544
    v_add_u32 v11, s33, v11
    v_xor_b32 v13, 16, v11
    v_mov_b32 v56, 0
    v_mov_b32 v57, 0
    v_mov_b32 v58, 0
    v_mov_b32 v59, 0
    v_mov_b32 v60, 0
    v_mov_b32 v61, 0
    v_mov_b32 v62, 0
    v_mov_b32 v63, 0
    v_mov_b32 v6, 156976
    s_lshl_b32 s32, s18, 12
    s_add_u32 s32, s32, 4259840
    v_lshlrev_b32 v54, 7, v1
    v_add_u32 v54, s32, v54
    s_lshl_b32 s32, s26, 12
    s_lshl_b32 s33, s25, 7
    s_add_u32 s32, s32, s33
    s_add_u32 s32, s32, 4259840
    v_mov_b32 v55, s32
    s_waitcnt vmcnt(0)
    s_mov_b64 exec, 1
    ds_add_rtn_u32 v53, v6, v7
    s_waitcnt lgkmcnt(0)
    v_readfirstlane_b32 s32, v53
    s_nop 0
    s_cmp_lg_u32 s32, 3
    s_cbranch_scc1 gmix_phase2_kernel_nosig
    s_mov_b32 exec_lo, -1
    buffer_atomic_add v7, v54, s[48:51], 0 offen sc1
    s_mov_b32 exec_lo, 1
gmix_phase2_kernel_nosig:
    s_cmp_lg_u32 s24, 0
    s_cbranch_scc1 gmix_phase2_kernel_lspin
gmix_phase2_kernel_spin:
    s_sleep 12
    buffer_load_dword v53, v55, s[48:51], 0 offen sc1
    s_waitcnt vmcnt(0)
    v_readfirstlane_b32 s32, v53
    s_nop 0
    s_cmp_ge_u32 s32, 32
    s_cbranch_scc1 gmix_phase2_kernel_seen
    s_sub_u32 s68, s68, 1
    s_cmp_lg_u32 s68, 0
    s_cbranch_scc1 gmix_phase2_kernel_spin
gmix_phase2_kernel_seen:
    ds_write_b32 v6, v7 offset:4
    s_branch gmix_phase2_kernel_go
gmix_phase2_kernel_lspin:
    s_sleep 1
    ds_read_b32 v53, v6 offset:4
    s_waitcnt lgkmcnt(0)
    v_readfirstlane_b32 s32, v53
    s_nop 0
    s_sub_u32 s68, s68, 1
    s_cmp_eq_u32 s68, 0
    s_cselect_b32 s32, 1, s32
    s_cmp_eq_u32 s32, 0
    s_cbranch_scc1 gmix_phase2_kernel_lspin
gmix_phase2_kernel_go:
    s_mov_b64 exec, -1
    buffer_load_dwordx4 v[48:51], v10, s[48:51], s39 offen sc1
    buffer_load_dwordx4 v[52:55], v10, s[48:51], s38 offen sc1
    v_mov_b32 v6, 156960
gmix_phase2_kernel_hs2:
    ds_read_b128 v[64:67], v6
    s_waitcnt lgkmcnt(0)
    v_and_b32 v64, v64, v65
    v_and_b32 v66, v66, v67
    v_and_b32 v64, v64, v66
    s_nop 0
    v_readfirstlane_b32 s32, v64
    s_nop 0
    s_sub_u32 s68, s68, 1
    s_cmp_eq_u32 s68, 0
    s_cselect_b32 s32, 1, s32
    s_cmp_eq_u32 s32, 0
    s_cbranch_scc1 gmix_phase2_kernel_hs2
    s_waitcnt vmcnt(1)
    ds_write_b128 v11, v[48:51]
    s_waitcnt vmcnt(0)
    ds_write_b128 v13, v[52:55] offset:1024
    s_waitcnt lgkmcnt(0)
    s_barrier
    ds_read_u16_d16_hi v56, v34 offset:0
    ds_read_u16_d16_hi v57, v34 offset:128
    ds_read_u16_d16_hi v58, v34 offset:256
    ds_read_u16_d16_hi v59, v34 offset:384
    ds_read_u16_d16_hi v60, v34 offset:512
    ds_read_u16_d16_hi v61, v34 offset:640
    ds_read_u16_d16_hi v62, v34 offset:768
    ds_read_u16_d16_hi v63, v34 offset:896
    ds_read_b128 v[72:75], v42 offset:0
    ds_read_b128 v[76:79], v43 offset:0
    ds_read_b128 v[80:83], v42 offset:28672
    ds_read_b128 v[84:87], v43 offset:28672
    ds_read_b128 v[88:91], v32 offset:0
    ds_read_b128 v[92:95], v33 offset:0
    ds_read_b128 v[96:99], v32 offset:28672
    ds_read_b128 v[100:103], v33 offset:28672
    s_waitcnt lgkmcnt(15)
    v_mul_f32 v16, v16, v56
    s_waitcnt lgkmcnt(14)
    v_mul_f32 v17, v17, v57
    s_waitcnt lgkmcnt(13)
    v_mul_f32 v18, v18, v58
    s_waitcnt lgkmcnt(12)
    v_mul_f32 v19, v19, v59
    s_waitcnt lgkmcnt(11)
    v_mul_f32 v20, v20, v60
    s_waitcnt lgkmcnt(10)
    v_mul_f32 v21, v21, v61
    s_waitcnt lgkmcnt(9)
    v_mul_f32 v22, v22, v62
    s_waitcnt lgkmcnt(8)
    v_mul_f32 v23, v23, v63
    s_waitcnt lgkmcnt(0)
    v_pk_add_f32 v[72:73], v[72:73], v[80:81]
    v_pk_add_f32 v[88:89], v[88:89], v[96:97]
    v_pk_add_f32 v[74:75], v[74:75], v[82:83]
    v_pk_add_f32 v[90:91], v[90:91], v[98:99]
    v_pk_add_f32 v[76:77], v[76:77], v[84:85]
    v_pk_add_f32 v[92:93], v[92:93], v[100:101]
    v_pk_add_f32 v[78:79], v[78:79], v[86:87]
    v_pk_add_f32 v[94:95], v[94:95], v[102:103]
    v_pk_add_f32 v[72:73], v[72:73], v[88:89]
    v_pk_add_f32 v[74:75], v[74:75], v[90:91]
    v_pk_add_f32 v[76:77], v[76:77], v[92:93]
    v_pk_add_f32 v[78:79], v[78:79], v[94:95]
    v_fma_f32 v72, v72, v2, v16
    v_fma_f32 v73, v73, v2, v17
    v_fma_f32 v74, v74, v2, v18
    v_fma_f32 v75, v75, v2, v19
    v_fma_f32 v76, v76, v2, v20
    v_fma_f32 v77, v77, v2, v21
    v_fma_f32 v78, v78, v2, v22
    v_fma_f32 v79, v79, v2, v23
    v_cvt_pk_bf16_f32 v80, v72, v73
    v_cvt_pk_bf16_f32 v81, v74, v75
    v_cvt_pk_bf16_f32 v82, v76, v77
    v_cvt_pk_bf16_f32 v83, v78, v79
    buffer_store_dwordx4 v[80:83], v12, s[44:47], 0 offen sc1
gmix_phase2_kernel_end:
    s_endpgm
.section .rodata,"a"
.p2align 6
.amdhsa_kernel gmix_phase1_kernel
  .amdhsa_next_free_vgpr 256
  .amdhsa_next_free_sgpr 102
  .amdhsa_accum_offset 256
  .amdhsa_group_segment_fixed_size 0
  .amdhsa_kernarg_size 112
  .amdhsa_user_sgpr_count 2
  .amdhsa_user_sgpr_kernarg_segment_ptr 1
  .amdhsa_system_sgpr_workgroup_id_x 1
.end_amdhsa_kernel
.p2align 6
.amdhsa_kernel gmix_phase2_kernel
  .amdhsa_next_free_vgpr 256
  .amdhsa_next_free_sgpr 90
  .amdhsa_accum_offset 256
  .amdhsa_group_segment_fixed_size 0
  .amdhsa_kernarg_size 112
  .amdhsa_user_sgpr_count 2
  .amdhsa_user_sgpr_kernarg_segment_ptr 1
  .amdhsa_system_sgpr_workgroup_id_x 1
.end_amdhsa_kernel
```
